```python
import torch

def _softmax(x, axis=-1):
    return torch.softmax(x, dim=axis)
def _gelu(x):
    return torch.nn.functional.gelu(x, approximate="tanh")
def _silu(x):
    return torch.nn.functional.silu(x)
def _sigmoid(x):
    return torch.sigmoid(x)
def _layernorm(x, axis=-1, eps=1e-5):
    m = x.mean(dim=axis, keepdim=True)
    v = x.var(dim=axis, keepdim=True, unbiased=False)
    return (x - m) / torch.sqrt(v + eps)
def _scatter_add(tgt, idx, src, axis=0):
    return tgt.clone().index_add_(axis, idx, src)
def _segment_sum(src, seg, n):
    out = torch.zeros((n,) + src.shape[1:], dtype=src.dtype)
    return out.index_add_(0, seg, src)
def _pad(x, pw):
    flat = tuple(v for pair in reversed(pw) for v in pair)
    return torch.nn.functional.pad(x, flat)

kernel_name = 'parallel_sum__gqa_block_cached__mixer_token_mlp__decode'

def setup_inputs():

    _w = (lambda a: (lambda t: t.to(torch.bfloat16) if t.is_floating_point() else t)(torch.as_tensor(a)))
    def _A_setup():
        B, Sq, D = 4, 1, 512
        Hq, Hkv, Sk, Dh = 32, 32, 8192, 128
        assert Hq % Hkv == 0, (Hq, Hkv)
        return {
            "x": _w((lambda *s: torch.randn(*s, dtype=torch.bfloat16) * 0.05)(B, Sq, D)),
            "k_cache": _w((lambda *s: torch.randn(*s, dtype=torch.bfloat16) * 3.2)(B, Hkv, Sk, Dh)),
            "v_cache": _w((lambda *s: torch.randn(*s, dtype=torch.bfloat16) * 0.8)(B, Hkv, Sk, Dh)),
            "wq": _w((lambda *s: torch.randn(*s, dtype=torch.bfloat16) * 3.2)(D, Hq * Dh) * (D ** -0.5)),
            "wo": _w((lambda *s: torch.randn(*s, dtype=torch.bfloat16) * 0.8)(Hq * Dh, D) * ((Hq * Dh) ** -0.5)),
        }
    _A_in = _A_setup()

    def _B_setup():
        B, S, D, F = 4, 1, 512, 1376
        return {
            "x": _w((lambda *s: torch.randn(*s, dtype=torch.bfloat16) * 0.05)(B, S, D)),
            "w1": _w((lambda *s: torch.randn(*s, dtype=torch.bfloat16) * 1.6)(S, F) * (S ** -0.5)),
            "b1": _w((lambda *s: torch.randn(*s, dtype=torch.bfloat16) * 1.6)(F) * 0.02),
            "w2": _w((lambda *s: torch.randn(*s, dtype=torch.bfloat16) * 1.6)(F, S) * (F ** -0.5)),
            "b2": _w((lambda *s: torch.randn(*s, dtype=torch.bfloat16) * 0.8)(S) * 0.02),
        }
    _B_in = _B_setup()

    return {
        "A_x": _A_in["x"],
        "A_k_cache": _A_in["k_cache"],
        "A_v_cache": _A_in["v_cache"],
        "A_wq": _A_in["wq"],
        "A_wo": _A_in["wo"],
        "B_x": _B_in["x"],
        "B_w1": _B_in["w1"],
        "B_b1": _B_in["b1"],
        "B_w2": _B_in["w2"],
        "B_b2": _B_in["b2"],
    }

def reference(A_x, A_k_cache, A_v_cache, A_wq, A_wo, B_x, B_w1, B_b1, B_w2, B_b2):
    def _A_ref(x, k_cache, v_cache, wq, wo):
        B, Sq, D = x.shape
        Hq, Dh = 32, 128
        Hkv = k_cache.shape[1]
        rep = Hq // Hkv
        q = (lambda x, *d: x.permute(*d))((x @ wq).reshape(B, Sq, Hq, Dh), 0, 2, 1, 3)
        k = (lambda x, n, axis: torch.repeat_interleave(x, n, dim=axis))(k_cache, rep, axis=1)
        v = (lambda x, n, axis: torch.repeat_interleave(x, n, dim=axis))(v_cache, rep, axis=1)
        scores = torch.einsum("bhqd,bhkd->bhqk", q, k) * (Dh ** -0.5)
        p = _softmax(scores, axis=-1)
        o = torch.einsum("bhqk,bhkd->bhqd", p, v)
        return (lambda x, *d: x.permute(*d))(o, 0, 2, 1, 3).reshape(B, Sq, Hq * Dh) @ wo

    def _B_ref(x, w1, b1, w2, b2):
        B, S, D = x.shape
        h = _layernorm(x, axis=-1)
        u = torch.einsum("bsd,sf->bdf", h, w1) + b1
        u = _gelu(u)
        y = torch.einsum("bdf,fs->bds", u, w2) + b2
        return (lambda x, *d: x.permute(*d))(y, 0, 2, 1)

    x = A_x
    xn = _layernorm(x, axis=-1)
    return x + _A_ref(xn, A_k_cache, A_v_cache, A_wq, A_wo) + _B_ref(xn, B_w1, B_b1, B_w2, B_b2)
```

```asm
; @launch grid=(256,1,1) block=(512,1,1) lds=16704
.amdgcn_target "amdgcn-amd-amdhsa--gfx950"
.text
.globl parallel_sum__gqa_block_cached__mixer_token_mlp__decode_kernel
.p2align 8
.type parallel_sum__gqa_block_cached__mixer_token_mlp__decode_kernel,@function
parallel_sum__gqa_block_cached__mixer_token_mlp__decode_kernel:
 s_cmpk_ge_u32 s2, 256
 s_cbranch_scc1 L_end
 s_load_dwordx2 s[32:33], s[0:1], 8
 s_load_dwordx16 s[8:23], s[0:1], 32
 v_readfirstlane_b32 s79, v0
 s_load_dwordx2 s[40:41], s[0:1], 24
 s_load_dwordx2 s[4:5], s[0:1], 0
 s_load_dwordx2 s[6:7], s[0:1], 96
 s_load_dwordx2 s[26:27], s[0:1], 16
 s_bitcmp1_b32 s79, 8
 s_cbranch_scc0 L_go
 s_and_b32 s3, s2, 7
 s_lshl_b32 s3, s3, 5
 s_lshr_b32 s24, s2, 3
 s_add_u32 s25, s3, s24
 s_sub_u32 s25, s25, 1
 s_lshl_b32 s25, s25, 14
 v_lshl_add_u32 v1, v0, 6, s25
 s_waitcnt lgkmcnt(0)
 global_load_dword v29, v1, s[8:9]
L_go:
 s_lshr_b32 s79, s79, 6
 v_and_b32 v30, 63, v0
 v_lshlrev_b32 v31, 4, v30
 s_bfe_u32 s78, s2, 0x30003
 s_and_b32 s71, s2, 7
 s_lshl3_add_u32 s78, s71, s78
 s_and_b32 s71, s2, 0xc0
 s_or_b32 s78, s78, s71
 s_and_b32 s60, s79, 3
 s_cmp_ge_u32 s79, 4
 s_cbranch_scc1 L_aux
 s_setprio 2
 s_lshr_b32 s65, s78, 1
 s_lshl_b32 s65, s65, 21
 s_bitcmp1_b32 s2, 0
 s_cselect_b32 s71, 0x001f6c00, 0
 s_xor_b32 s65, s65, s71
 s_bitcmp1_b32 s2, 1
 s_cselect_b32 s71, 0x0001af00, 0
 s_xor_b32 s65, s65, s71
 s_bitcmp1_b32 s2, 2
 s_cselect_b32 s71, 0x00083d00, 0
 s_xor_b32 s65, s65, s71
 s_bitcmp1_b32 s2, 3
 s_cselect_b32 s71, 0x00095400, 0
 s_xor_b32 s65, s65, s71
 s_bitcmp1_b32 s2, 4
 s_cselect_b32 s71, 0x00060000, 0
 s_xor_b32 s65, s65, s71
 s_bitcmp1_b32 s2, 5
 s_cselect_b32 s71, 0x0014d000, 0
 s_xor_b32 s65, s65, s71
 s_bitcmp1_b32 s2, 6
 s_cselect_b32 s71, 0x00026100, 0
 s_xor_b32 s65, s65, s71
 s_bitcmp1_b32 s2, 7
 s_cselect_b32 s71, 0x0011cc00, 0
 s_xor_b32 s65, s65, s71
 s_bitcmp1_b32 s79, 0
 s_cselect_b32 s71, 0x001d5e00, 0
 s_xor_b32 s65, s65, s71
 s_bitcmp1_b32 s79, 1
 s_cselect_b32 s71, 0x000e0800, 0
 s_xor_b32 s65, s65, s71
 v_and_b32 v5, 0xf0, v31
 v_bfe_i32 v6, v30, 4, 1
 v_and_b32 v6, 0x000ca400, v6
 v_xor_b32 v5, v5, v6
 v_bfe_i32 v6, v30, 5, 1
 v_and_b32 v6, 0x00047300, v6
 v_xor_b32 v5, v5, v6
 s_mov_b32 s64, s65
 s_mov_b32 s34, 0x10000000
 s_mov_b32 s35, 0x00020000
 s_waitcnt lgkmcnt(0)
 v_xor_b32 v6, s64, v5
 buffer_load_dwordx4 v[32:35], v6, s[32:35], 0 offen nt
 s_xor_b32 s51, s64, 0x00057100
 v_xor_b32 v6, s51, v5
 buffer_load_dwordx4 v[36:39], v6, s[32:35], 0 offen nt
 s_xor_b32 s51, s64, 0x000a5d00
 v_xor_b32 v6, s51, v5
 buffer_load_dwordx4 v[40:43], v6, s[32:35], 0 offen nt
 s_xor_b32 s51, s64, 0x000f2c00
 v_xor_b32 v6, s51, v5
 buffer_load_dwordx4 v[44:47], v6, s[32:35], 0 offen nt
 s_xor_b32 s51, s64, 0x00088d00
 v_xor_b32 v6, s51, v5
 buffer_load_dwordx4 v[48:51], v6, s[32:35], 0 offen nt
 s_xor_b32 s51, s64, 0x000dfc00
 v_xor_b32 v6, s51, v5
 buffer_load_dwordx4 v[52:55], v6, s[32:35], 0 offen nt
 v_mov_b32 v7, 0
 v_bfe_i32 v16, v30, 0, 1
 v_and_b32 v16, 0x000f3e00, v16
 v_xor_b32 v7, v7, v16
 v_bfe_i32 v16, v30, 1, 1
 v_and_b32 v16, 0x000b2b00, v16
 v_xor_b32 v7, v7, v16
 v_bfe_i32 v16, v30, 2, 1
 v_and_b32 v16, 0x0006e400, v16
 v_xor_b32 v7, v7, v16
 v_bfe_i32 v16, v30, 3, 1
 v_and_b32 v16, 0x001f2000, v16
 v_xor_b32 v7, v7, v16
 v_bfe_i32 v16, v30, 4, 1
 v_and_b32 v16, 0x000d0a00, v16
 v_xor_b32 v7, v7, v16
 s_mov_b32 s48, 0
 v_and_b32 v16, 15, v30
 v_and_b32 v17, 1, v30
 v_lshlrev_b32 v17, 4, v17
 v_mov_b32 v18, 0xffff
 v_lshlrev_b32 v18, v17, v18
 v_lshrrev_b32 v19, 1, v16
 v_cmp_eq_u32 vcc, 0, v19
 s_nop 1
 v_cndmask_b32 v8, 0, v18, vcc
 v_cmp_eq_u32 vcc, 1, v19
 s_nop 1
 v_cndmask_b32 v9, 0, v18, vcc
 v_cmp_eq_u32 vcc, 2, v19
 s_nop 1
 v_cndmask_b32 v10, 0, v18, vcc
 v_cmp_eq_u32 vcc, 3, v19
 s_nop 1
 v_cndmask_b32 v11, 0, v18, vcc
 v_lshlrev_b32 v3, 5, v16
 v_and_b32 v17, 16, v30
 v_or_b32 v3, v3, v17
 v_and_b32 v17, 32, v30
 v_lshl_or_b32 v3, v17, 7, v3
 s_lshl_b32 s71, s60, 9
 v_add_u32 v3, s71, v3
 v_lshrrev_b32 v3, 1, v3
 s_mul_i32 s71, s60, 16
 v_add_u32 v3, s71, v3
 v_mov_b32 v4, v31
 s_mov_b32 s69, 0x3db504f3
 s_mov_b32 s70, 0x3fb8aa3b
 v_mov_b32 v1, 0xff800000
 s_lshl_b32 s71, s60, 11
 v_and_b32 v2, 60, v30
 v_add_u32 v2, s71, v2
 v_and_b32 v0, 15, v30
 v_lshlrev_b32 v0, 5, v0
 s_mov_b32 s66, 25
 s_xor_b32 s51, s64, 0x0002d000
 v_xor_b32 v6, s51, v5
 s_waitcnt vmcnt(5)
 buffer_load_dwordx4 v[56:59], v6, s[32:35], 0 offen nt
 s_xor_b32 s51, s64, 0x0007a100
 v_xor_b32 v6, s51, v5
 s_waitcnt vmcnt(5)
 buffer_load_dwordx4 v[60:63], v6, s[32:35], 0 offen nt
 s_add_u32 s48, s48, 1
 v_readlane_b32 s67, v7, s48
 s_xor_b32 s64, s65, s67
 v_xor_b32 v6, s64, v5
 s_waitcnt vmcnt(5)
 buffer_load_dwordx4 v[64:67], v6, s[32:35], 0 offen nt
 s_xor_b32 s51, s64, 0x00057100
 v_xor_b32 v6, s51, v5
 s_waitcnt vmcnt(5)
 buffer_load_dwordx4 v[68:71], v6, s[32:35], 0 offen nt
 s_xor_b32 s51, s64, 0x000a5d00
 v_xor_b32 v6, s51, v5
 s_waitcnt vmcnt(5)
 buffer_load_dwordx4 v[72:75], v6, s[32:35], 0 offen nt
 s_xor_b32 s51, s64, 0x000f2c00
 v_xor_b32 v6, s51, v5
 s_waitcnt vmcnt(5)
 buffer_load_dwordx4 v[76:79], v6, s[32:35], 0 offen nt
 s_xor_b32 s51, s64, 0x00088d00
 v_xor_b32 v6, s51, v5
 s_waitcnt vmcnt(5)
 buffer_load_dwordx4 v[80:83], v6, s[32:35], 0 offen nt
 s_xor_b32 s51, s64, 0x000dfc00
 v_xor_b32 v6, s51, v5
 s_waitcnt vmcnt(5)
 buffer_load_dwordx4 v[84:87], v6, s[32:35], 0 offen nt
 s_xor_b32 s51, s64, 0x0002d000
 v_xor_b32 v6, s51, v5
 s_waitcnt vmcnt(5)
 buffer_load_dwordx4 v[88:91], v6, s[32:35], 0 offen nt
 s_xor_b32 s51, s64, 0x0007a100
 v_xor_b32 v6, s51, v5
 s_waitcnt vmcnt(5)
 buffer_load_dwordx4 v[92:95], v6, s[32:35], 0 offen nt
 s_add_u32 s48, s48, 1
 v_readlane_b32 s67, v7, s48
 s_xor_b32 s64, s65, s67
 v_xor_b32 v6, s64, v5
 s_waitcnt vmcnt(5)
 buffer_load_dwordx4 v[96:99], v6, s[32:35], 0 offen nt
 s_xor_b32 s51, s64, 0x00057100
 v_xor_b32 v6, s51, v5
 s_waitcnt vmcnt(5)
 buffer_load_dwordx4 v[100:103], v6, s[32:35], 0 offen nt
 s_xor_b32 s51, s64, 0x000a5d00
 v_xor_b32 v6, s51, v5
 s_waitcnt vmcnt(5)
 buffer_load_dwordx4 v[104:107], v6, s[32:35], 0 offen nt
 s_xor_b32 s51, s64, 0x000f2c00
 v_xor_b32 v6, s51, v5
 s_waitcnt vmcnt(5)
 buffer_load_dwordx4 v[108:111], v6, s[32:35], 0 offen nt
 s_xor_b32 s51, s64, 0x00088d00
 v_xor_b32 v6, s51, v5
 s_waitcnt vmcnt(5)
 buffer_load_dwordx4 v[112:115], v6, s[32:35], 0 offen nt
 s_xor_b32 s51, s64, 0x000dfc00
 v_xor_b32 v6, s51, v5
 s_waitcnt vmcnt(5)
 buffer_load_dwordx4 v[116:119], v6, s[32:35], 0 offen nt
 s_xor_b32 s51, s64, 0x0002d000
 v_xor_b32 v6, s51, v5
 s_waitcnt vmcnt(5)
 buffer_load_dwordx4 v[120:123], v6, s[32:35], 0 offen nt
 s_xor_b32 s51, s64, 0x0007a100
 v_xor_b32 v6, s51, v5
 s_waitcnt vmcnt(5)
 buffer_load_dwordx4 v[124:127], v6, s[32:35], 0 offen nt
 s_add_u32 s48, s48, 1
 v_readlane_b32 s67, v7, s48
 s_xor_b32 s64, s65, s67
 v_xor_b32 v6, s64, v5
 s_waitcnt vmcnt(5)
 buffer_load_dwordx4 v[128:131], v6, s[32:35], 0 offen nt
 s_xor_b32 s51, s64, 0x00057100
 v_xor_b32 v6, s51, v5
 s_waitcnt vmcnt(5)
 buffer_load_dwordx4 v[132:135], v6, s[32:35], 0 offen nt
 s_xor_b32 s51, s64, 0x000a5d00
 v_xor_b32 v6, s51, v5
 s_waitcnt vmcnt(5)
 buffer_load_dwordx4 v[136:139], v6, s[32:35], 0 offen nt
 s_xor_b32 s51, s64, 0x000f2c00
 v_xor_b32 v6, s51, v5
 s_waitcnt vmcnt(5)
 buffer_load_dwordx4 v[140:143], v6, s[32:35], 0 offen nt
 s_xor_b32 s51, s64, 0x00088d00
 v_xor_b32 v6, s51, v5
 s_waitcnt vmcnt(5)
 buffer_load_dwordx4 v[144:147], v6, s[32:35], 0 offen nt
 s_xor_b32 s51, s64, 0x000dfc00
 v_xor_b32 v6, s51, v5
 s_waitcnt vmcnt(5)
 buffer_load_dwordx4 v[148:151], v6, s[32:35], 0 offen nt
 s_xor_b32 s51, s64, 0x0002d000
 v_xor_b32 v6, s51, v5
 s_waitcnt vmcnt(5)
 buffer_load_dwordx4 v[152:155], v6, s[32:35], 0 offen nt
 s_xor_b32 s51, s64, 0x0007a100
 v_xor_b32 v6, s51, v5
 s_waitcnt vmcnt(5)
 buffer_load_dwordx4 v[156:159], v6, s[32:35], 0 offen nt
 s_add_u32 s48, s48, 1
 v_readlane_b32 s67, v7, s48
 s_xor_b32 s64, s65, s67
 v_xor_b32 v6, s64, v5
 s_waitcnt vmcnt(4)
 buffer_load_dwordx4 v[160:163], v6, s[32:35], 0 offen nt
 s_xor_b32 s51, s64, 0x00057100
 v_xor_b32 v6, s51, v5
 s_waitcnt vmcnt(4)
 buffer_load_dwordx4 v[164:167], v6, s[32:35], 0 offen nt
 s_xor_b32 s51, s64, 0x000a5d00
 v_xor_b32 v6, s51, v5
 s_waitcnt vmcnt(4)
 buffer_load_dwordx4 v[168:171], v6, s[32:35], 0 offen nt
 s_xor_b32 s51, s64, 0x000f2c00
 v_xor_b32 v6, s51, v5
 s_waitcnt vmcnt(4)
 buffer_load_dwordx4 v[172:175], v6, s[32:35], 0 offen nt
 s_xor_b32 s51, s64, 0x00088d00
 v_xor_b32 v6, s51, v5
 s_waitcnt vmcnt(4)
 buffer_load_dwordx4 v[176:179], v6, s[32:35], 0 offen nt
 s_xor_b32 s51, s64, 0x000dfc00
 v_xor_b32 v6, s51, v5
 s_waitcnt vmcnt(4)
 buffer_load_dwordx4 v[180:183], v6, s[32:35], 0 offen nt
 s_xor_b32 s51, s64, 0x0002d000
 v_xor_b32 v6, s51, v5
 s_waitcnt vmcnt(4)
 buffer_load_dwordx4 v[184:187], v6, s[32:35], 0 offen nt
 s_xor_b32 s51, s64, 0x0007a100
 v_xor_b32 v6, s51, v5
 s_waitcnt vmcnt(4)
 buffer_load_dwordx4 v[188:191], v6, s[32:35], 0 offen nt
 s_add_u32 s48, s48, 1
 v_readlane_b32 s67, v7, s48
 s_xor_b32 s64, s65, s67
 v_xor_b32 v6, s64, v5
 s_waitcnt vmcnt(4)
 buffer_load_dwordx4 v[192:195], v6, s[32:35], 0 offen nt
 s_xor_b32 s51, s64, 0x00057100
 v_xor_b32 v6, s51, v5
 s_waitcnt vmcnt(4)
 buffer_load_dwordx4 v[196:199], v6, s[32:35], 0 offen nt
 s_xor_b32 s51, s64, 0x000a5d00
 v_xor_b32 v6, s51, v5
 s_waitcnt vmcnt(4)
 buffer_load_dwordx4 v[200:203], v6, s[32:35], 0 offen nt
 s_xor_b32 s51, s64, 0x000f2c00
 v_xor_b32 v6, s51, v5
 s_waitcnt vmcnt(4)
 buffer_load_dwordx4 v[204:207], v6, s[32:35], 0 offen nt
 s_xor_b32 s51, s64, 0x00088d00
 v_xor_b32 v6, s51, v5
 s_waitcnt vmcnt(4)
 buffer_load_dwordx4 v[208:211], v6, s[32:35], 0 offen nt
 s_xor_b32 s51, s64, 0x000dfc00
 v_xor_b32 v6, s51, v5
 s_waitcnt vmcnt(4)
 buffer_load_dwordx4 v[212:215], v6, s[32:35], 0 offen nt
 s_xor_b32 s51, s64, 0x0002d000
 v_xor_b32 v6, s51, v5
 s_waitcnt vmcnt(4)
 buffer_load_dwordx4 v[216:219], v6, s[32:35], 0 offen nt
 s_xor_b32 s51, s64, 0x0007a100
 v_xor_b32 v6, s51, v5
 s_waitcnt vmcnt(4)
 buffer_load_dwordx4 v[220:223], v6, s[32:35], 0 offen nt
 s_add_u32 s48, s48, 1
 v_readlane_b32 s67, v7, s48
 s_xor_b32 s64, s65, s67
 v_xor_b32 v6, s64, v5
 s_waitcnt vmcnt(4)
 buffer_load_dwordx4 v[224:227], v6, s[32:35], 0 offen nt
 s_xor_b32 s51, s64, 0x00057100
 v_xor_b32 v6, s51, v5
 s_waitcnt vmcnt(4)
 buffer_load_dwordx4 v[228:231], v6, s[32:35], 0 offen nt
 s_xor_b32 s51, s64, 0x000a5d00
 v_xor_b32 v6, s51, v5
 s_waitcnt vmcnt(4)
 buffer_load_dwordx4 v[232:235], v6, s[32:35], 0 offen nt
 s_xor_b32 s51, s64, 0x000f2c00
 v_xor_b32 v6, s51, v5
 s_waitcnt vmcnt(4)
 buffer_load_dwordx4 v[236:239], v6, s[32:35], 0 offen nt
 s_xor_b32 s51, s64, 0x00088d00
 v_xor_b32 v6, s51, v5
 buffer_load_dwordx4 v[240:243], v6, s[32:35], 0 offen nt
 s_xor_b32 s51, s64, 0x000dfc00
 v_xor_b32 v6, s51, v5
 buffer_load_dwordx4 v[244:247], v6, s[32:35], 0 offen nt
 s_xor_b32 s51, s64, 0x0002d000
 v_xor_b32 v6, s51, v5
 buffer_load_dwordx4 v[248:251], v6, s[32:35], 0 offen nt
 s_xor_b32 s51, s64, 0x0007a100
 v_xor_b32 v6, s51, v5
 buffer_load_dwordx4 v[252:255], v6, s[32:35], 0 offen nt
 s_add_u32 s48, s48, 1
 v_readlane_b32 s67, v7, s48
 s_xor_b32 s64, s65, s67
 s_barrier
 ds_read_b128 v[16:19], v0 offset:0
 ds_read_b128 v[20:23], v0 offset:512
 ds_read_b128 v[24:27], v0 offset:1024
 ds_read_b128 v[28:31], v0 offset:1536
 s_waitcnt lgkmcnt(0)
 v_add_f32 v16, v16, v20
 v_add_f32 v17, v17, v21
 v_add_f32 v18, v18, v22
 v_add_f32 v19, v19, v23
 v_add_f32 v24, v24, v28
 v_add_f32 v25, v25, v29
 v_add_f32 v26, v26, v30
 v_add_f32 v27, v27, v31
 v_add_f32 v16, v16, v24
 v_add_f32 v17, v17, v25
 v_add_f32 v18, v18, v26
 v_add_f32 v19, v19, v27
 v_cvt_pk_bf16_f32 v12, v16, v17
 v_cvt_pk_bf16_f32 v13, v18, v19
 ds_read_b128 v[16:19], v0 offset:16
 ds_read_b128 v[20:23], v0 offset:528
 ds_read_b128 v[24:27], v0 offset:1040
 ds_read_b128 v[28:31], v0 offset:1552
 s_waitcnt lgkmcnt(0)
 v_add_f32 v16, v16, v20
 v_add_f32 v17, v17, v21
 v_add_f32 v18, v18, v22
 v_add_f32 v19, v19, v23
 v_add_f32 v24, v24, v28
 v_add_f32 v25, v25, v29
 v_add_f32 v26, v26, v30
 v_add_f32 v27, v27, v31
 v_add_f32 v16, v16, v24
 v_add_f32 v17, v17, v25
 v_add_f32 v18, v18, v26
 v_add_f32 v19, v19, v27
 v_cvt_pk_bf16_f32 v14, v16, v17
 v_cvt_pk_bf16_f32 v15, v18, v19
 s_waitcnt vmcnt(48)
 v_dot2_f32_bf16 v16, v32, v12, 0
 v_dot2_f32_bf16 v17, v36, v12, 0
 v_dot2_f32_bf16 v18, v40, v12, 0
 v_dot2_f32_bf16 v19, v44, v12, 0
 v_dot2_f32_bf16 v20, v48, v12, 0
 v_dot2_f32_bf16 v21, v52, v12, 0
 v_dot2_f32_bf16 v22, v56, v12, 0
 v_dot2_f32_bf16 v23, v60, v12, 0
 v_dot2_f32_bf16 v16, v33, v13, v16
 v_dot2_f32_bf16 v17, v37, v13, v17
 v_dot2_f32_bf16 v18, v41, v13, v18
 v_dot2_f32_bf16 v19, v45, v13, v19
 v_dot2_f32_bf16 v20, v49, v13, v20
 v_dot2_f32_bf16 v21, v53, v13, v21
 v_dot2_f32_bf16 v22, v57, v13, v22
 v_dot2_f32_bf16 v23, v61, v13, v23
 v_dot2_f32_bf16 v16, v34, v14, v16
 v_dot2_f32_bf16 v17, v38, v14, v17
 v_dot2_f32_bf16 v18, v42, v14, v18
 v_dot2_f32_bf16 v19, v46, v14, v19
 v_dot2_f32_bf16 v20, v50, v14, v20
 v_dot2_f32_bf16 v21, v54, v14, v21
 v_dot2_f32_bf16 v22, v58, v14, v22
 v_dot2_f32_bf16 v23, v62, v14, v23
 v_dot2_f32_bf16 v16, v35, v15, v16
 v_dot2_f32_bf16 v17, v39, v15, v17
 v_dot2_f32_bf16 v18, v43, v15, v18
 v_dot2_f32_bf16 v19, v47, v15, v19
 v_dot2_f32_bf16 v20, v51, v15, v20
 v_dot2_f32_bf16 v21, v55, v15, v21
 v_dot2_f32_bf16 v22, v59, v15, v22
 v_dot2_f32_bf16 v23, v63, v15, v23
 v_xor_b32 v6, s64, v5
 buffer_load_dwordx4 v[32:35], v6, s[32:35], 0 offen nt
 s_xor_b32 s51, s64, 0x00057100
 v_xor_b32 v6, s51, v5
 buffer_load_dwordx4 v[36:39], v6, s[32:35], 0 offen nt
 s_xor_b32 s51, s64, 0x000a5d00
 v_xor_b32 v6, s51, v5
 buffer_load_dwordx4 v[40:43], v6, s[32:35], 0 offen nt
 s_xor_b32 s51, s64, 0x000f2c00
 v_xor_b32 v6, s51, v5
 buffer_load_dwordx4 v[44:47], v6, s[32:35], 0 offen nt
 s_xor_b32 s51, s64, 0x00088d00
 v_xor_b32 v6, s51, v5
 buffer_load_dwordx4 v[48:51], v6, s[32:35], 0 offen nt
 s_xor_b32 s51, s64, 0x000dfc00
 v_xor_b32 v6, s51, v5
 buffer_load_dwordx4 v[52:55], v6, s[32:35], 0 offen nt
 s_xor_b32 s51, s64, 0x0002d000
 v_xor_b32 v6, s51, v5
 buffer_load_dwordx4 v[56:59], v6, s[32:35], 0 offen nt
 v_add_f32_dpp v24, v16, v16 row_ror:8 row_mask:0xf bank_mask:0x3
 v_add_f32_dpp v25, v17, v17 row_ror:8 row_mask:0xf bank_mask:0x3
 v_add_f32_dpp v26, v20, v20 row_ror:8 row_mask:0xf bank_mask:0x3
 v_add_f32_dpp v27, v21, v21 row_ror:8 row_mask:0xf bank_mask:0x3
 v_add_f32_dpp v24, v18, v18 row_ror:8 row_mask:0xf bank_mask:0xc
 v_add_f32_dpp v25, v19, v19 row_ror:8 row_mask:0xf bank_mask:0xc
 v_add_f32_dpp v26, v22, v22 row_ror:8 row_mask:0xf bank_mask:0xc
 v_add_f32_dpp v27, v23, v23 row_ror:8 row_mask:0xf bank_mask:0xc
 v_add_f32_dpp v28, v24, v24 row_half_mirror row_mask:0xf bank_mask:0x5
 v_add_f32_dpp v29, v26, v26 row_half_mirror row_mask:0xf bank_mask:0x5
 s_nop 0
 v_add_f32_dpp v28, v25, v25 row_half_mirror row_mask:0xf bank_mask:0xa
 v_add_f32_dpp v29, v27, v27 row_half_mirror row_mask:0xf bank_mask:0xa
 s_nop 0
 v_add_f32_dpp v28, v28, v28 quad_perm:[1,0,3,2] row_mask:0xf bank_mask:0xf
 v_add_f32_dpp v29, v29, v29 quad_perm:[1,0,3,2] row_mask:0xf bank_mask:0xf
 s_nop 0
 v_add_f32_dpp v28, v28, v28 quad_perm:[2,3,0,1] row_mask:0xf bank_mask:0xf
 v_add_f32_dpp v29, v29, v29 quad_perm:[2,3,0,1] row_mask:0xf bank_mask:0xf
 v_cvt_pk_bf16_f32 v0, v28, v29
 v_lshlrev_b32 v28, 16, v0
 v_and_b32 v29, 0xffff0000, v0
 v_mul_f32 v28, s69, v28
 v_mul_f32 v29, s69, v29
 v_cvt_pk_bf16_f32 v0, v28, v29
 v_lshlrev_b32 v28, 16, v0
 v_and_b32 v29, 0xffff0000, v0
 ds_write_b32 v2, v0 offset:8448
 v_max3_f32 v1, v28, v29, v1
 v_add_u32 v2, 64, v2
 s_waitcnt vmcnt(47)
 v_dot2_f32_bf16 v16, v64, v12, 0
 v_dot2_f32_bf16 v17, v68, v12, 0
 v_dot2_f32_bf16 v18, v72, v12, 0
 v_dot2_f32_bf16 v19, v76, v12, 0
 v_dot2_f32_bf16 v20, v80, v12, 0
 v_dot2_f32_bf16 v21, v84, v12, 0
 v_dot2_f32_bf16 v22, v88, v12, 0
 v_dot2_f32_bf16 v23, v92, v12, 0
 v_dot2_f32_bf16 v16, v65, v13, v16
 v_dot2_f32_bf16 v17, v69, v13, v17
 v_dot2_f32_bf16 v18, v73, v13, v18
 v_dot2_f32_bf16 v19, v77, v13, v19
 v_dot2_f32_bf16 v20, v81, v13, v20
 v_dot2_f32_bf16 v21, v85, v13, v21
 v_dot2_f32_bf16 v22, v89, v13, v22
 v_dot2_f32_bf16 v23, v93, v13, v23
 v_dot2_f32_bf16 v16, v66, v14, v16
 v_dot2_f32_bf16 v17, v70, v14, v17
 v_dot2_f32_bf16 v18, v74, v14, v18
 v_dot2_f32_bf16 v19, v78, v14, v19
 v_dot2_f32_bf16 v20, v82, v14, v20
 v_dot2_f32_bf16 v21, v86, v14, v21
 v_dot2_f32_bf16 v22, v90, v14, v22
 v_dot2_f32_bf16 v23, v94, v14, v23
 v_dot2_f32_bf16 v16, v67, v15, v16
 v_dot2_f32_bf16 v17, v71, v15, v17
 v_dot2_f32_bf16 v18, v75, v15, v18
 v_dot2_f32_bf16 v19, v79, v15, v19
 v_dot2_f32_bf16 v20, v83, v15, v20
 v_dot2_f32_bf16 v21, v87, v15, v21
 v_dot2_f32_bf16 v22, v91, v15, v22
 v_dot2_f32_bf16 v23, v95, v15, v23
 v_add_f32_dpp v24, v16, v16 row_ror:8 row_mask:0xf bank_mask:0x3
 v_add_f32_dpp v25, v17, v17 row_ror:8 row_mask:0xf bank_mask:0x3
 v_add_f32_dpp v26, v20, v20 row_ror:8 row_mask:0xf bank_mask:0x3
 v_add_f32_dpp v27, v21, v21 row_ror:8 row_mask:0xf bank_mask:0x3
 v_add_f32_dpp v24, v18, v18 row_ror:8 row_mask:0xf bank_mask:0xc
 v_add_f32_dpp v25, v19, v19 row_ror:8 row_mask:0xf bank_mask:0xc
 v_add_f32_dpp v26, v22, v22 row_ror:8 row_mask:0xf bank_mask:0xc
 v_add_f32_dpp v27, v23, v23 row_ror:8 row_mask:0xf bank_mask:0xc
 v_add_f32_dpp v28, v24, v24 row_half_mirror row_mask:0xf bank_mask:0x5
 v_add_f32_dpp v29, v26, v26 row_half_mirror row_mask:0xf bank_mask:0x5
 s_nop 0
 v_add_f32_dpp v28, v25, v25 row_half_mirror row_mask:0xf bank_mask:0xa
 v_add_f32_dpp v29, v27, v27 row_half_mirror row_mask:0xf bank_mask:0xa
 s_nop 0
 v_add_f32_dpp v28, v28, v28 quad_perm:[1,0,3,2] row_mask:0xf bank_mask:0xf
 v_add_f32_dpp v29, v29, v29 quad_perm:[1,0,3,2] row_mask:0xf bank_mask:0xf
 s_nop 0
 v_add_f32_dpp v28, v28, v28 quad_perm:[2,3,0,1] row_mask:0xf bank_mask:0xf
 v_add_f32_dpp v29, v29, v29 quad_perm:[2,3,0,1] row_mask:0xf bank_mask:0xf
 v_cvt_pk_bf16_f32 v0, v28, v29
 v_lshlrev_b32 v28, 16, v0
 v_and_b32 v29, 0xffff0000, v0
 v_mul_f32 v28, s69, v28
 v_mul_f32 v29, s69, v29
 v_cvt_pk_bf16_f32 v0, v28, v29
 v_lshlrev_b32 v28, 16, v0
 v_and_b32 v29, 0xffff0000, v0
 ds_write_b32 v2, v0 offset:8448
 v_max3_f32 v1, v28, v29, v1
 v_add_u32 v2, 64, v2
 s_waitcnt vmcnt(39)
 v_dot2_f32_bf16 v16, v96, v12, 0
 v_dot2_f32_bf16 v17, v100, v12, 0
 v_dot2_f32_bf16 v18, v104, v12, 0
 v_dot2_f32_bf16 v19, v108, v12, 0
 v_dot2_f32_bf16 v20, v112, v12, 0
 v_dot2_f32_bf16 v21, v116, v12, 0
 v_dot2_f32_bf16 v22, v120, v12, 0
 v_dot2_f32_bf16 v23, v124, v12, 0
 v_dot2_f32_bf16 v16, v97, v13, v16
 v_dot2_f32_bf16 v17, v101, v13, v17
 v_dot2_f32_bf16 v18, v105, v13, v18
 v_dot2_f32_bf16 v19, v109, v13, v19
 v_dot2_f32_bf16 v20, v113, v13, v20
 v_dot2_f32_bf16 v21, v117, v13, v21
 v_dot2_f32_bf16 v22, v121, v13, v22
 v_dot2_f32_bf16 v23, v125, v13, v23
 v_dot2_f32_bf16 v16, v98, v14, v16
 v_dot2_f32_bf16 v17, v102, v14, v17
 v_dot2_f32_bf16 v18, v106, v14, v18
 v_dot2_f32_bf16 v19, v110, v14, v19
 v_dot2_f32_bf16 v20, v114, v14, v20
 v_dot2_f32_bf16 v21, v118, v14, v21
 v_dot2_f32_bf16 v22, v122, v14, v22
 v_dot2_f32_bf16 v23, v126, v14, v23
 v_dot2_f32_bf16 v16, v99, v15, v16
 v_dot2_f32_bf16 v17, v103, v15, v17
 v_dot2_f32_bf16 v18, v107, v15, v18
 v_dot2_f32_bf16 v19, v111, v15, v19
 v_dot2_f32_bf16 v20, v115, v15, v20
 v_dot2_f32_bf16 v21, v119, v15, v21
 v_dot2_f32_bf16 v22, v123, v15, v22
 v_dot2_f32_bf16 v23, v127, v15, v23
 v_add_f32_dpp v24, v16, v16 row_ror:8 row_mask:0xf bank_mask:0x3
 v_add_f32_dpp v25, v17, v17 row_ror:8 row_mask:0xf bank_mask:0x3
 v_add_f32_dpp v26, v20, v20 row_ror:8 row_mask:0xf bank_mask:0x3
 v_add_f32_dpp v27, v21, v21 row_ror:8 row_mask:0xf bank_mask:0x3
 v_add_f32_dpp v24, v18, v18 row_ror:8 row_mask:0xf bank_mask:0xc
 v_add_f32_dpp v25, v19, v19 row_ror:8 row_mask:0xf bank_mask:0xc
 v_add_f32_dpp v26, v22, v22 row_ror:8 row_mask:0xf bank_mask:0xc
 v_add_f32_dpp v27, v23, v23 row_ror:8 row_mask:0xf bank_mask:0xc
 v_add_f32_dpp v28, v24, v24 row_half_mirror row_mask:0xf bank_mask:0x5
 v_add_f32_dpp v29, v26, v26 row_half_mirror row_mask:0xf bank_mask:0x5
 s_nop 0
 v_add_f32_dpp v28, v25, v25 row_half_mirror row_mask:0xf bank_mask:0xa
 v_add_f32_dpp v29, v27, v27 row_half_mirror row_mask:0xf bank_mask:0xa
 s_nop 0
 v_add_f32_dpp v28, v28, v28 quad_perm:[1,0,3,2] row_mask:0xf bank_mask:0xf
 v_add_f32_dpp v29, v29, v29 quad_perm:[1,0,3,2] row_mask:0xf bank_mask:0xf
 s_nop 0
 v_add_f32_dpp v28, v28, v28 quad_perm:[2,3,0,1] row_mask:0xf bank_mask:0xf
 v_add_f32_dpp v29, v29, v29 quad_perm:[2,3,0,1] row_mask:0xf bank_mask:0xf
 v_cvt_pk_bf16_f32 v0, v28, v29
 v_lshlrev_b32 v28, 16, v0
 v_and_b32 v29, 0xffff0000, v0
 v_mul_f32 v28, s69, v28
 v_mul_f32 v29, s69, v29
 v_cvt_pk_bf16_f32 v0, v28, v29
 v_lshlrev_b32 v28, 16, v0
 v_and_b32 v29, 0xffff0000, v0
 ds_write_b32 v2, v0 offset:8448
 v_max3_f32 v1, v28, v29, v1
 v_add_u32 v2, 64, v2
 s_waitcnt vmcnt(31)
 v_dot2_f32_bf16 v16, v128, v12, 0
 v_dot2_f32_bf16 v17, v132, v12, 0
 v_dot2_f32_bf16 v18, v136, v12, 0
 v_dot2_f32_bf16 v19, v140, v12, 0
 v_dot2_f32_bf16 v20, v144, v12, 0
 v_dot2_f32_bf16 v21, v148, v12, 0
 v_dot2_f32_bf16 v22, v152, v12, 0
 v_dot2_f32_bf16 v23, v156, v12, 0
 v_dot2_f32_bf16 v16, v129, v13, v16
 v_dot2_f32_bf16 v17, v133, v13, v17
 v_dot2_f32_bf16 v18, v137, v13, v18
 v_dot2_f32_bf16 v19, v141, v13, v19
 v_dot2_f32_bf16 v20, v145, v13, v20
 v_dot2_f32_bf16 v21, v149, v13, v21
 v_dot2_f32_bf16 v22, v153, v13, v22
 v_dot2_f32_bf16 v23, v157, v13, v23
 v_dot2_f32_bf16 v16, v130, v14, v16
 v_dot2_f32_bf16 v17, v134, v14, v17
 v_dot2_f32_bf16 v18, v138, v14, v18
 v_dot2_f32_bf16 v19, v142, v14, v19
 v_dot2_f32_bf16 v20, v146, v14, v20
 v_dot2_f32_bf16 v21, v150, v14, v21
 v_dot2_f32_bf16 v22, v154, v14, v22
 v_dot2_f32_bf16 v23, v158, v14, v23
 v_dot2_f32_bf16 v16, v131, v15, v16
 v_dot2_f32_bf16 v17, v135, v15, v17
 v_dot2_f32_bf16 v18, v139, v15, v18
 v_dot2_f32_bf16 v19, v143, v15, v19
 v_dot2_f32_bf16 v20, v147, v15, v20
 v_dot2_f32_bf16 v21, v151, v15, v21
 v_dot2_f32_bf16 v22, v155, v15, v22
 v_dot2_f32_bf16 v23, v159, v15, v23
 v_add_f32_dpp v24, v16, v16 row_ror:8 row_mask:0xf bank_mask:0x3
 v_add_f32_dpp v25, v17, v17 row_ror:8 row_mask:0xf bank_mask:0x3
 v_add_f32_dpp v26, v20, v20 row_ror:8 row_mask:0xf bank_mask:0x3
 v_add_f32_dpp v27, v21, v21 row_ror:8 row_mask:0xf bank_mask:0x3
 v_add_f32_dpp v24, v18, v18 row_ror:8 row_mask:0xf bank_mask:0xc
 v_add_f32_dpp v25, v19, v19 row_ror:8 row_mask:0xf bank_mask:0xc
 v_add_f32_dpp v26, v22, v22 row_ror:8 row_mask:0xf bank_mask:0xc
 v_add_f32_dpp v27, v23, v23 row_ror:8 row_mask:0xf bank_mask:0xc
 v_add_f32_dpp v28, v24, v24 row_half_mirror row_mask:0xf bank_mask:0x5
 v_add_f32_dpp v29, v26, v26 row_half_mirror row_mask:0xf bank_mask:0x5
 s_nop 0
 v_add_f32_dpp v28, v25, v25 row_half_mirror row_mask:0xf bank_mask:0xa
 v_add_f32_dpp v29, v27, v27 row_half_mirror row_mask:0xf bank_mask:0xa
 s_nop 0
 v_add_f32_dpp v28, v28, v28 quad_perm:[1,0,3,2] row_mask:0xf bank_mask:0xf
 v_add_f32_dpp v29, v29, v29 quad_perm:[1,0,3,2] row_mask:0xf bank_mask:0xf
 s_nop 0
 v_add_f32_dpp v28, v28, v28 quad_perm:[2,3,0,1] row_mask:0xf bank_mask:0xf
 v_add_f32_dpp v29, v29, v29 quad_perm:[2,3,0,1] row_mask:0xf bank_mask:0xf
 v_cvt_pk_bf16_f32 v0, v28, v29
 v_lshlrev_b32 v28, 16, v0
 v_and_b32 v29, 0xffff0000, v0
 v_mul_f32 v28, s69, v28
 v_mul_f32 v29, s69, v29
 v_cvt_pk_bf16_f32 v0, v28, v29
 v_lshlrev_b32 v28, 16, v0
 v_and_b32 v29, 0xffff0000, v0
 ds_write_b32 v2, v0 offset:8448
 v_max3_f32 v1, v28, v29, v1
 v_add_u32 v2, 64, v2
 s_waitcnt vmcnt(23)
 v_dot2_f32_bf16 v16, v160, v12, 0
 v_dot2_f32_bf16 v17, v164, v12, 0
 v_dot2_f32_bf16 v18, v168, v12, 0
 v_dot2_f32_bf16 v19, v172, v12, 0
 v_dot2_f32_bf16 v20, v176, v12, 0
 v_dot2_f32_bf16 v21, v180, v12, 0
 v_dot2_f32_bf16 v22, v184, v12, 0
 v_dot2_f32_bf16 v23, v188, v12, 0
 v_dot2_f32_bf16 v16, v161, v13, v16
 v_dot2_f32_bf16 v17, v165, v13, v17
 v_dot2_f32_bf16 v18, v169, v13, v18
 v_dot2_f32_bf16 v19, v173, v13, v19
 v_dot2_f32_bf16 v20, v177, v13, v20
 v_dot2_f32_bf16 v21, v181, v13, v21
 v_dot2_f32_bf16 v22, v185, v13, v22
 v_dot2_f32_bf16 v23, v189, v13, v23
 v_dot2_f32_bf16 v16, v162, v14, v16
 v_dot2_f32_bf16 v17, v166, v14, v17
 v_dot2_f32_bf16 v18, v170, v14, v18
 v_dot2_f32_bf16 v19, v174, v14, v19
 v_dot2_f32_bf16 v20, v178, v14, v20
 v_dot2_f32_bf16 v21, v182, v14, v21
 v_dot2_f32_bf16 v22, v186, v14, v22
 v_dot2_f32_bf16 v23, v190, v14, v23
 v_dot2_f32_bf16 v16, v163, v15, v16
 v_dot2_f32_bf16 v17, v167, v15, v17
 v_dot2_f32_bf16 v18, v171, v15, v18
 v_dot2_f32_bf16 v19, v175, v15, v19
 v_dot2_f32_bf16 v20, v179, v15, v20
 v_dot2_f32_bf16 v21, v183, v15, v21
 v_dot2_f32_bf16 v22, v187, v15, v22
 v_dot2_f32_bf16 v23, v191, v15, v23
 v_add_f32_dpp v24, v16, v16 row_ror:8 row_mask:0xf bank_mask:0x3
 v_add_f32_dpp v25, v17, v17 row_ror:8 row_mask:0xf bank_mask:0x3
 v_add_f32_dpp v26, v20, v20 row_ror:8 row_mask:0xf bank_mask:0x3
 v_add_f32_dpp v27, v21, v21 row_ror:8 row_mask:0xf bank_mask:0x3
 v_add_f32_dpp v24, v18, v18 row_ror:8 row_mask:0xf bank_mask:0xc
 v_add_f32_dpp v25, v19, v19 row_ror:8 row_mask:0xf bank_mask:0xc
 v_add_f32_dpp v26, v22, v22 row_ror:8 row_mask:0xf bank_mask:0xc
 v_add_f32_dpp v27, v23, v23 row_ror:8 row_mask:0xf bank_mask:0xc
 v_add_f32_dpp v28, v24, v24 row_half_mirror row_mask:0xf bank_mask:0x5
 v_add_f32_dpp v29, v26, v26 row_half_mirror row_mask:0xf bank_mask:0x5
 s_nop 0
 v_add_f32_dpp v28, v25, v25 row_half_mirror row_mask:0xf bank_mask:0xa
 v_add_f32_dpp v29, v27, v27 row_half_mirror row_mask:0xf bank_mask:0xa
 s_nop 0
 v_add_f32_dpp v28, v28, v28 quad_perm:[1,0,3,2] row_mask:0xf bank_mask:0xf
 v_add_f32_dpp v29, v29, v29 quad_perm:[1,0,3,2] row_mask:0xf bank_mask:0xf
 s_nop 0
 v_add_f32_dpp v28, v28, v28 quad_perm:[2,3,0,1] row_mask:0xf bank_mask:0xf
 v_add_f32_dpp v29, v29, v29 quad_perm:[2,3,0,1] row_mask:0xf bank_mask:0xf
 v_cvt_pk_bf16_f32 v0, v28, v29
 v_lshlrev_b32 v28, 16, v0
 v_and_b32 v29, 0xffff0000, v0
 v_mul_f32 v28, s69, v28
 v_mul_f32 v29, s69, v29
 v_cvt_pk_bf16_f32 v0, v28, v29
 v_lshlrev_b32 v28, 16, v0
 v_and_b32 v29, 0xffff0000, v0
 ds_write_b32 v2, v0 offset:8448
 v_max3_f32 v1, v28, v29, v1
 v_add_u32 v2, 64, v2
 s_waitcnt vmcnt(15)
 v_dot2_f32_bf16 v16, v192, v12, 0
 v_dot2_f32_bf16 v17, v196, v12, 0
 v_dot2_f32_bf16 v18, v200, v12, 0
 v_dot2_f32_bf16 v19, v204, v12, 0
 v_dot2_f32_bf16 v20, v208, v12, 0
 v_dot2_f32_bf16 v21, v212, v12, 0
 v_dot2_f32_bf16 v22, v216, v12, 0
 v_dot2_f32_bf16 v23, v220, v12, 0
 v_dot2_f32_bf16 v16, v193, v13, v16
 v_dot2_f32_bf16 v17, v197, v13, v17
 v_dot2_f32_bf16 v18, v201, v13, v18
 v_dot2_f32_bf16 v19, v205, v13, v19
 v_dot2_f32_bf16 v20, v209, v13, v20
 v_dot2_f32_bf16 v21, v213, v13, v21
 v_dot2_f32_bf16 v22, v217, v13, v22
 v_dot2_f32_bf16 v23, v221, v13, v23
 v_dot2_f32_bf16 v16, v194, v14, v16
 v_dot2_f32_bf16 v17, v198, v14, v17
 v_dot2_f32_bf16 v18, v202, v14, v18
 v_dot2_f32_bf16 v19, v206, v14, v19
 v_dot2_f32_bf16 v20, v210, v14, v20
 v_dot2_f32_bf16 v21, v214, v14, v21
 v_dot2_f32_bf16 v22, v218, v14, v22
 v_dot2_f32_bf16 v23, v222, v14, v23
 v_dot2_f32_bf16 v16, v195, v15, v16
 v_dot2_f32_bf16 v17, v199, v15, v17
 v_dot2_f32_bf16 v18, v203, v15, v18
 v_dot2_f32_bf16 v19, v207, v15, v19
 v_dot2_f32_bf16 v20, v211, v15, v20
 v_dot2_f32_bf16 v21, v215, v15, v21
 v_dot2_f32_bf16 v22, v219, v15, v22
 v_dot2_f32_bf16 v23, v223, v15, v23
 v_add_f32_dpp v24, v16, v16 row_ror:8 row_mask:0xf bank_mask:0x3
 v_add_f32_dpp v25, v17, v17 row_ror:8 row_mask:0xf bank_mask:0x3
 v_add_f32_dpp v26, v20, v20 row_ror:8 row_mask:0xf bank_mask:0x3
 v_add_f32_dpp v27, v21, v21 row_ror:8 row_mask:0xf bank_mask:0x3
 v_add_f32_dpp v24, v18, v18 row_ror:8 row_mask:0xf bank_mask:0xc
 v_add_f32_dpp v25, v19, v19 row_ror:8 row_mask:0xf bank_mask:0xc
 v_add_f32_dpp v26, v22, v22 row_ror:8 row_mask:0xf bank_mask:0xc
 v_add_f32_dpp v27, v23, v23 row_ror:8 row_mask:0xf bank_mask:0xc
 v_add_f32_dpp v28, v24, v24 row_half_mirror row_mask:0xf bank_mask:0x5
 v_add_f32_dpp v29, v26, v26 row_half_mirror row_mask:0xf bank_mask:0x5
 s_nop 0
 v_add_f32_dpp v28, v25, v25 row_half_mirror row_mask:0xf bank_mask:0xa
 v_add_f32_dpp v29, v27, v27 row_half_mirror row_mask:0xf bank_mask:0xa
 s_nop 0
 v_add_f32_dpp v28, v28, v28 quad_perm:[1,0,3,2] row_mask:0xf bank_mask:0xf
 v_add_f32_dpp v29, v29, v29 quad_perm:[1,0,3,2] row_mask:0xf bank_mask:0xf
 s_nop 0
 v_add_f32_dpp v28, v28, v28 quad_perm:[2,3,0,1] row_mask:0xf bank_mask:0xf
 v_add_f32_dpp v29, v29, v29 quad_perm:[2,3,0,1] row_mask:0xf bank_mask:0xf
 v_cvt_pk_bf16_f32 v0, v28, v29
 v_lshlrev_b32 v28, 16, v0
 v_and_b32 v29, 0xffff0000, v0
 v_mul_f32 v28, s69, v28
 v_mul_f32 v29, s69, v29
 v_cvt_pk_bf16_f32 v0, v28, v29
 v_lshlrev_b32 v28, 16, v0
 v_and_b32 v29, 0xffff0000, v0
 ds_write_b32 v2, v0 offset:8448
 v_max3_f32 v1, v28, v29, v1
 v_add_u32 v2, 64, v2
 s_waitcnt vmcnt(7)
 v_dot2_f32_bf16 v16, v224, v12, 0
 v_dot2_f32_bf16 v17, v228, v12, 0
 v_dot2_f32_bf16 v18, v232, v12, 0
 v_dot2_f32_bf16 v19, v236, v12, 0
 v_dot2_f32_bf16 v20, v240, v12, 0
 v_dot2_f32_bf16 v21, v244, v12, 0
 v_dot2_f32_bf16 v22, v248, v12, 0
 v_dot2_f32_bf16 v23, v252, v12, 0
 v_dot2_f32_bf16 v16, v225, v13, v16
 v_dot2_f32_bf16 v17, v229, v13, v17
 v_dot2_f32_bf16 v18, v233, v13, v18
 v_dot2_f32_bf16 v19, v237, v13, v19
 v_dot2_f32_bf16 v20, v241, v13, v20
 v_dot2_f32_bf16 v21, v245, v13, v21
 v_dot2_f32_bf16 v22, v249, v13, v22
 v_dot2_f32_bf16 v23, v253, v13, v23
 v_dot2_f32_bf16 v16, v226, v14, v16
 v_dot2_f32_bf16 v17, v230, v14, v17
 v_dot2_f32_bf16 v18, v234, v14, v18
 v_dot2_f32_bf16 v19, v238, v14, v19
 v_dot2_f32_bf16 v20, v242, v14, v20
 v_dot2_f32_bf16 v21, v246, v14, v21
 v_dot2_f32_bf16 v22, v250, v14, v22
 v_dot2_f32_bf16 v23, v254, v14, v23
 v_dot2_f32_bf16 v16, v227, v15, v16
 v_dot2_f32_bf16 v17, v231, v15, v17
 v_dot2_f32_bf16 v18, v235, v15, v18
 v_dot2_f32_bf16 v19, v239, v15, v19
 v_dot2_f32_bf16 v20, v243, v15, v20
 v_dot2_f32_bf16 v21, v247, v15, v21
 v_dot2_f32_bf16 v22, v251, v15, v22
 v_dot2_f32_bf16 v23, v255, v15, v23
 v_add_f32_dpp v24, v16, v16 row_ror:8 row_mask:0xf bank_mask:0x3
 v_add_f32_dpp v25, v17, v17 row_ror:8 row_mask:0xf bank_mask:0x3
 v_add_f32_dpp v26, v20, v20 row_ror:8 row_mask:0xf bank_mask:0x3
 v_add_f32_dpp v27, v21, v21 row_ror:8 row_mask:0xf bank_mask:0x3
 v_add_f32_dpp v24, v18, v18 row_ror:8 row_mask:0xf bank_mask:0xc
 v_add_f32_dpp v25, v19, v19 row_ror:8 row_mask:0xf bank_mask:0xc
 v_add_f32_dpp v26, v22, v22 row_ror:8 row_mask:0xf bank_mask:0xc
 v_add_f32_dpp v27, v23, v23 row_ror:8 row_mask:0xf bank_mask:0xc
 v_add_f32_dpp v28, v24, v24 row_half_mirror row_mask:0xf bank_mask:0x5
 v_add_f32_dpp v29, v26, v26 row_half_mirror row_mask:0xf bank_mask:0x5
 s_nop 0
 v_add_f32_dpp v28, v25, v25 row_half_mirror row_mask:0xf bank_mask:0xa
 v_add_f32_dpp v29, v27, v27 row_half_mirror row_mask:0xf bank_mask:0xa
 s_nop 0
 v_add_f32_dpp v28, v28, v28 quad_perm:[1,0,3,2] row_mask:0xf bank_mask:0xf
 v_add_f32_dpp v29, v29, v29 quad_perm:[1,0,3,2] row_mask:0xf bank_mask:0xf
 s_nop 0
 v_add_f32_dpp v28, v28, v28 quad_perm:[2,3,0,1] row_mask:0xf bank_mask:0xf
 v_add_f32_dpp v29, v29, v29 quad_perm:[2,3,0,1] row_mask:0xf bank_mask:0xf
 v_cvt_pk_bf16_f32 v0, v28, v29
 v_lshlrev_b32 v28, 16, v0
 v_and_b32 v29, 0xffff0000, v0
 v_mul_f32 v28, s69, v28
 v_mul_f32 v29, s69, v29
 v_cvt_pk_bf16_f32 v0, v28, v29
 v_lshlrev_b32 v28, 16, v0
 v_and_b32 v29, 0xffff0000, v0
 ds_write_b32 v2, v0 offset:8448
 v_max3_f32 v1, v28, v29, v1
 v_add_u32 v2, 64, v2
 s_and_b32 s71, s2, 7
 s_lshl_b32 s71, s71, 10
 s_add_u32 s71, s71, 589824
 s_lshr_b32 s72, s2, 3
 s_lshl2_add_u32 s72, s72, s60
 s_lshl2_add_u32 s72, s72, s71
 v_mov_b32 v96, s72
 v_min_u32 v97, 512, v4
 v_add_u32 v97, s71, v97
 v_mov_b32 v100, 0
 v_mov_b32 v101, 0
 v_mov_b32 v102, 0
 v_mov_b32 v103, 0
 v_writelane_b32 v100, 64, 32
 s_mov_b32 s28, 1
 s_mov_b32 s3, 0
 s_mov_b64 vcc, -1
L_kloop:
 s_xor_b32 s51, s64, 0x0007a100
 v_xor_b32 v6, s51, v5
 s_cbranch_vccz L_k0_late
 s_waitcnt vmcnt(4)
 buffer_load_dwordx4 v[60:63], v6, s[32:35], 0 offen nt
L_k0:
 v_dot2_f32_bf16 v16, v32, v12, 0
 v_dot2_f32_bf16 v16, v33, v13, v16
 v_dot2_f32_bf16 v16, v34, v14, v16
 v_dot2_f32_bf16 v16, v35, v15, v16
 v_cmp_le_u32 s[24:25], s28, v100
 v_cmp_le_u32 s[30:31], s28, v101
 v_cmp_le_u32 s[36:37], s28, v102
 v_cmp_le_u32 s[38:39], s28, v103
 v_readlane_b32 s85, v100, 32
 s_mov_b32 s25, s30
 s_mov_b32 s37, s38
 s_bcnt1_i32_b64 s29, s[24:25]
 s_bcnt1_i32_b64 s71, s[36:37]
 s_add_u32 s29, s29, s71
 s_add_u32 s28, s28, 1
 v_cmp_le_u32 s[24:25], s28, v101
 s_bcnt1_i32_b32 s3, s24
 s_add_u32 s29, s29, 8
 s_cmp_ge_u32 s29, s85
 s_cselect_b64 vcc, 0, -1
 s_add_u32 s48, s48, 1
 v_readlane_b32 s67, v7, s48
 s_xor_b32 s64, s65, s67
 s_sub_u32 s66, s66, 1
 s_cmp_eq_u32 s66, 0
 s_cselect_b32 s32, s26, s32
 s_cselect_b32 s33, s27, s33
 v_xor_b32 v6, s64, v5
 s_cbranch_vccz L_k1_late
 s_waitcnt vmcnt(4)
 buffer_load_dwordx4 v[32:35], v6, s[32:35], 0 offen nt
L_k1:
 v_mov_b32 v98, s28
 global_load_dwordx4 v[100:103], v97, s[6:7] nt
 s_mov_b64 exec, 1
 global_store_dword v96, v98, s[6:7]
 s_mov_b64 exec, -1
 v_dot2_f32_bf16 v17, v36, v12, 0
 v_dot2_f32_bf16 v17, v37, v13, v17
 v_dot2_f32_bf16 v17, v38, v14, v17
 v_dot2_f32_bf16 v17, v39, v15, v17
 s_xor_b32 s51, s64, 0x00057100
 v_xor_b32 v6, s51, v5
 s_cbranch_vccz L_k2_late
 s_waitcnt vmcnt(6)
 buffer_load_dwordx4 v[36:39], v6, s[32:35], 0 offen nt
L_k2:
 v_dot2_f32_bf16 v18, v40, v12, 0
 v_dot2_f32_bf16 v18, v41, v13, v18
 v_dot2_f32_bf16 v18, v42, v14, v18
 v_dot2_f32_bf16 v18, v43, v15, v18
 s_xor_b32 s51, s64, 0x000a5d00
 v_xor_b32 v6, s51, v5
 s_cbranch_vccz L_k3_late
 s_waitcnt vmcnt(6)
 buffer_load_dwordx4 v[40:43], v6, s[32:35], 0 offen nt
L_k3:
 v_dot2_f32_bf16 v19, v44, v12, 0
 v_dot2_f32_bf16 v19, v45, v13, v19
 v_dot2_f32_bf16 v19, v46, v14, v19
 v_dot2_f32_bf16 v19, v47, v15, v19
 s_xor_b32 s51, s64, 0x000f2c00
 v_xor_b32 v6, s51, v5
 s_cbranch_vccz L_k4_late
 s_waitcnt vmcnt(6)
 buffer_load_dwordx4 v[44:47], v6, s[32:35], 0 offen nt
L_k4:
 v_dot2_f32_bf16 v20, v48, v12, 0
 v_dot2_f32_bf16 v20, v49, v13, v20
 v_dot2_f32_bf16 v20, v50, v14, v20
 v_dot2_f32_bf16 v20, v51, v15, v20
 s_xor_b32 s51, s64, 0x00088d00
 v_xor_b32 v6, s51, v5
 s_cbranch_vccz L_k5_late
 s_waitcnt vmcnt(6)
 buffer_load_dwordx4 v[48:51], v6, s[32:35], 0 offen nt
L_k5:
 v_dot2_f32_bf16 v21, v52, v12, 0
 v_dot2_f32_bf16 v21, v53, v13, v21
 v_dot2_f32_bf16 v21, v54, v14, v21
 v_dot2_f32_bf16 v21, v55, v15, v21
 s_xor_b32 s51, s64, 0x000dfc00
 v_xor_b32 v6, s51, v5
 s_cbranch_vccz L_k6_late
 s_waitcnt vmcnt(4)
 buffer_load_dwordx4 v[52:55], v6, s[32:35], 0 offen nt
L_k6:
 v_dot2_f32_bf16 v22, v56, v12, 0
 v_dot2_f32_bf16 v22, v57, v13, v22
 v_dot2_f32_bf16 v22, v58, v14, v22
 v_dot2_f32_bf16 v22, v59, v15, v22
 s_xor_b32 s51, s64, 0x0002d000
 v_xor_b32 v6, s51, v5
 s_cbranch_vccz L_k7_late
 s_waitcnt vmcnt(4)
 buffer_load_dwordx4 v[56:59], v6, s[32:35], 0 offen nt
L_k7:
 v_dot2_f32_bf16 v23, v60, v12, 0
 v_dot2_f32_bf16 v23, v61, v13, v23
 v_dot2_f32_bf16 v23, v62, v14, v23
 v_dot2_f32_bf16 v23, v63, v15, v23
 v_add_f32_dpp v24, v16, v16 row_ror:8 row_mask:0xf bank_mask:0x3
 v_add_f32_dpp v25, v17, v17 row_ror:8 row_mask:0xf bank_mask:0x3
 v_add_f32_dpp v26, v20, v20 row_ror:8 row_mask:0xf bank_mask:0x3
 v_add_f32_dpp v27, v21, v21 row_ror:8 row_mask:0xf bank_mask:0x3
 v_add_f32_dpp v24, v18, v18 row_ror:8 row_mask:0xf bank_mask:0xc
 v_add_f32_dpp v25, v19, v19 row_ror:8 row_mask:0xf bank_mask:0xc
 v_add_f32_dpp v26, v22, v22 row_ror:8 row_mask:0xf bank_mask:0xc
 v_add_f32_dpp v27, v23, v23 row_ror:8 row_mask:0xf bank_mask:0xc
 v_add_f32_dpp v28, v24, v24 row_half_mirror row_mask:0xf bank_mask:0x5
 v_add_f32_dpp v29, v26, v26 row_half_mirror row_mask:0xf bank_mask:0x5
 s_nop 0
 v_add_f32_dpp v28, v25, v25 row_half_mirror row_mask:0xf bank_mask:0xa
 v_add_f32_dpp v29, v27, v27 row_half_mirror row_mask:0xf bank_mask:0xa
 s_nop 0
 v_add_f32_dpp v28, v28, v28 quad_perm:[1,0,3,2] row_mask:0xf bank_mask:0xf
 v_add_f32_dpp v29, v29, v29 quad_perm:[1,0,3,2] row_mask:0xf bank_mask:0xf
 s_nop 0
 v_add_f32_dpp v28, v28, v28 quad_perm:[2,3,0,1] row_mask:0xf bank_mask:0xf
 v_add_f32_dpp v29, v29, v29 quad_perm:[2,3,0,1] row_mask:0xf bank_mask:0xf
 v_cvt_pk_bf16_f32 v0, v28, v29
 v_lshlrev_b32 v28, 16, v0
 v_and_b32 v29, 0xffff0000, v0
 v_mul_f32 v28, s69, v28
 v_mul_f32 v29, s69, v29
 v_cvt_pk_bf16_f32 v0, v28, v29
 v_lshlrev_b32 v28, 16, v0
 v_and_b32 v29, 0xffff0000, v0
 ds_write_b32 v2, v0 offset:8448
 v_max3_f32 v1, v28, v29, v1
 v_add_u32 v2, 64, v2
 s_cmp_lg_u32 s66, 0
 s_cbranch_scc1 L_kloop
 v_subrev_u32 v2, 2048, v2
 v_mov_b32 v24, 0
 ds_read_b32 v27, v2 offset:8448
 v_mov_b32 v12, 0
 v_mov_b32 v13, 0
 v_mov_b32 v14, 0
 v_mov_b32 v15, 0
 s_nop 1
 v_max_f32_dpp v1, v1, v1 row_half_mirror row_mask:0xf bank_mask:0xf
 s_nop 1
 v_max_f32_dpp v1, v1, v1 row_mirror row_mask:0xf bank_mask:0xf
 s_nop 1
 v_max_f32_dpp v1, v1, v1 row_bcast:15 row_mask:0xa bank_mask:0xf
 s_nop 1
 v_max_f32_dpp v1, v1, v1 row_bcast:31 row_mask:0xc bank_mask:0xf
 s_mov_b32 s66, 32
 v_readlane_b32 s68, v1, 63
L_vloop:
 s_waitcnt lgkmcnt(0)
 v_lshlrev_b32 v28, 16, v27
 v_and_b32 v29, 0xffff0000, v27
 ds_read_b32 v27, v2 offset:8512
 v_subrev_f32 v28, s68, v28
 v_subrev_f32 v29, s68, v29
 v_mul_f32 v28, s70, v28
 v_mul_f32 v29, s70, v29
 v_exp_f32 v28, v28
 v_exp_f32 v29, v29
 v_add_u32 v2, 64, v2
 v_cvt_pk_bf16_f32 v25, v28, v28
 v_cvt_pk_bf16_f32 v26, v29, v29
 v_add_f32 v24, v24, v28
 v_add_f32 v24, v24, v29
 v_and_b32_dpp v16, v25, v8 row_newbcast:0 row_mask:0xf bank_mask:0xf
 v_and_b32_dpp v17, v25, v9 row_newbcast:0 row_mask:0xf bank_mask:0xf
 v_and_b32_dpp v18, v25, v10 row_newbcast:0 row_mask:0xf bank_mask:0xf
 v_and_b32_dpp v19, v25, v11 row_newbcast:0 row_mask:0xf bank_mask:0xf
 s_xor_b32 s51, s64, 0x0007a100
 v_xor_b32 v6, s51, v5
 s_cbranch_vccz L_v0_0_late
 s_waitcnt vmcnt(4)
 buffer_load_dwordx4 v[60:63], v6, s[32:35], 0 offen nt
L_v0_0:
 v_mfma_f32_16x16x32_bf16 v[12:15], v[16:19], v[32:35], v[12:15]
 v_and_b32_dpp v20, v25, v8 row_newbcast:4 row_mask:0xf bank_mask:0xf
 v_and_b32_dpp v21, v25, v9 row_newbcast:4 row_mask:0xf bank_mask:0xf
 v_and_b32_dpp v22, v25, v10 row_newbcast:4 row_mask:0xf bank_mask:0xf
 v_and_b32_dpp v23, v25, v11 row_newbcast:4 row_mask:0xf bank_mask:0xf
 s_sub_u32 s66, s66, 1
 s_cmp_eq_u32 s66, 0
 s_cbranch_scc1 L_last
 v_cmp_le_u32 s[24:25], s28, v100
 v_cmp_le_u32 s[30:31], s28, v101
 v_cmp_le_u32 s[36:37], s28, v102
 v_cmp_le_u32 s[38:39], s28, v103
 v_readlane_b32 s85, v100, 32
 s_mov_b32 s25, s30
 s_mov_b32 s37, s38
 s_bcnt1_i32_b64 s29, s[24:25]
 s_bcnt1_i32_b64 s71, s[36:37]
 s_add_u32 s29, s29, s71
 s_add_u32 s28, s28, 1
 v_cmp_le_u32 s[24:25], s28, v101
 s_bcnt1_i32_b32 s3, s24
 s_cmp_ge_u32 s29, s85
 s_cselect_b64 vcc, 0, -1
 s_add_u32 s48, s48, 1
 v_readlane_b32 s67, v7, s48
 s_xor_b32 s64, s65, s67
 v_xor_b32 v6, s64, v5
 s_cbranch_vccz L_v0_1_late
 s_waitcnt vmcnt(4)
 buffer_load_dwordx4 v[32:35], v6, s[32:35], 0 offen nt
L_v0_1:
 v_mfma_f32_16x16x32_bf16 v[12:15], v[20:23], v[36:39], v[12:15]
 v_mov_b32 v98, s28
 global_load_dwordx4 v[100:103], v97, s[6:7] nt
 s_mov_b64 exec, 1
 global_store_dword v96, v98, s[6:7]
 s_mov_b64 exec, -1
 v_and_b32_dpp v16, v25, v8 row_newbcast:8 row_mask:0xf bank_mask:0xf
 v_and_b32_dpp v17, v25, v9 row_newbcast:8 row_mask:0xf bank_mask:0xf
 v_and_b32_dpp v18, v25, v10 row_newbcast:8 row_mask:0xf bank_mask:0xf
 v_and_b32_dpp v19, v25, v11 row_newbcast:8 row_mask:0xf bank_mask:0xf
 s_xor_b32 s51, s64, 0x00057100
 v_xor_b32 v6, s51, v5
 s_cbranch_vccz L_v0_2_late
 s_waitcnt vmcnt(6)
 buffer_load_dwordx4 v[36:39], v6, s[32:35], 0 offen nt
L_v0_2:
 v_mfma_f32_16x16x32_bf16 v[12:15], v[16:19], v[40:43], v[12:15]
 v_and_b32_dpp v20, v25, v8 row_newbcast:12 row_mask:0xf bank_mask:0xf
 v_and_b32_dpp v21, v25, v9 row_newbcast:12 row_mask:0xf bank_mask:0xf
 v_and_b32_dpp v22, v25, v10 row_newbcast:12 row_mask:0xf bank_mask:0xf
 v_and_b32_dpp v23, v25, v11 row_newbcast:12 row_mask:0xf bank_mask:0xf
 s_xor_b32 s51, s64, 0x000a5d00
 v_xor_b32 v6, s51, v5
 s_cbranch_vccz L_v0_3_late
 s_waitcnt vmcnt(6)
 buffer_load_dwordx4 v[40:43], v6, s[32:35], 0 offen nt
L_v0_3:
 v_mfma_f32_16x16x32_bf16 v[12:15], v[20:23], v[44:47], v[12:15]
 v_and_b32_dpp v16, v26, v8 row_newbcast:0 row_mask:0xf bank_mask:0xf
 v_and_b32_dpp v17, v26, v9 row_newbcast:0 row_mask:0xf bank_mask:0xf
 v_and_b32_dpp v18, v26, v10 row_newbcast:0 row_mask:0xf bank_mask:0xf
 v_and_b32_dpp v19, v26, v11 row_newbcast:0 row_mask:0xf bank_mask:0xf
 s_xor_b32 s51, s64, 0x000f2c00
 v_xor_b32 v6, s51, v5
 s_cbranch_vccz L_v0_4_late
 s_waitcnt vmcnt(6)
 buffer_load_dwordx4 v[44:47], v6, s[32:35], 0 offen nt
L_v0_4:
 v_mfma_f32_16x16x32_bf16 v[12:15], v[16:19], v[48:51], v[12:15]
 v_and_b32_dpp v20, v26, v8 row_newbcast:4 row_mask:0xf bank_mask:0xf
 v_and_b32_dpp v21, v26, v9 row_newbcast:4 row_mask:0xf bank_mask:0xf
 v_and_b32_dpp v22, v26, v10 row_newbcast:4 row_mask:0xf bank_mask:0xf
 v_and_b32_dpp v23, v26, v11 row_newbcast:4 row_mask:0xf bank_mask:0xf
 s_xor_b32 s51, s64, 0x00088d00
 v_xor_b32 v6, s51, v5
 s_cbranch_vccz L_v0_5_late
 s_waitcnt vmcnt(6)
 buffer_load_dwordx4 v[48:51], v6, s[32:35], 0 offen nt
L_v0_5:
 v_mfma_f32_16x16x32_bf16 v[12:15], v[20:23], v[52:55], v[12:15]
 v_and_b32_dpp v16, v26, v8 row_newbcast:8 row_mask:0xf bank_mask:0xf
 v_and_b32_dpp v17, v26, v9 row_newbcast:8 row_mask:0xf bank_mask:0xf
 v_and_b32_dpp v18, v26, v10 row_newbcast:8 row_mask:0xf bank_mask:0xf
 v_and_b32_dpp v19, v26, v11 row_newbcast:8 row_mask:0xf bank_mask:0xf
 s_xor_b32 s51, s64, 0x000dfc00
 v_xor_b32 v6, s51, v5
 s_cbranch_vccz L_v0_6_late
 s_waitcnt vmcnt(4)
 buffer_load_dwordx4 v[52:55], v6, s[32:35], 0 offen nt
L_v0_6:
 v_mfma_f32_16x16x32_bf16 v[12:15], v[16:19], v[56:59], v[12:15]
 v_and_b32_dpp v20, v26, v8 row_newbcast:12 row_mask:0xf bank_mask:0xf
 v_and_b32_dpp v21, v26, v9 row_newbcast:12 row_mask:0xf bank_mask:0xf
 v_and_b32_dpp v22, v26, v10 row_newbcast:12 row_mask:0xf bank_mask:0xf
 v_and_b32_dpp v23, v26, v11 row_newbcast:12 row_mask:0xf bank_mask:0xf
 s_xor_b32 s51, s64, 0x0002d000
 v_xor_b32 v6, s51, v5
 s_cbranch_vccz L_v0_7_late
 s_waitcnt vmcnt(4)
 buffer_load_dwordx4 v[56:59], v6, s[32:35], 0 offen nt
L_v0_7:
 v_mfma_f32_16x16x32_bf16 v[12:15], v[20:23], v[60:63], v[12:15]
 s_branch L_vloop
L_k0_late:
 s_cmp_ge_u32 s3, 3
 s_waitcnt vmcnt(6)
 s_cbranch_scc1 L_k0_far
 s_waitcnt vmcnt(5)
L_k0_far:
 buffer_load_dwordx4 v[60:63], v6, s[32:35], 0 offen nt
 s_branch L_k0
L_k1_late:
 s_cmp_ge_u32 s3, 3
 s_waitcnt vmcnt(6)
 s_cbranch_scc1 L_k1_far
 s_waitcnt vmcnt(5)
L_k1_far:
 buffer_load_dwordx4 v[32:35], v6, s[32:35], 0 offen nt
 s_branch L_k1
L_k2_late:
 s_cmp_ge_u32 s3, 3
 s_waitcnt vmcnt(8)
 s_cbranch_scc1 L_k2_far
 s_waitcnt vmcnt(7)
L_k2_far:
 buffer_load_dwordx4 v[36:39], v6, s[32:35], 0 offen nt
 s_branch L_k2
L_k3_late:
 s_cmp_ge_u32 s3, 3
 s_waitcnt vmcnt(8)
 s_cbranch_scc1 L_k3_far
 s_waitcnt vmcnt(7)
L_k3_far:
 buffer_load_dwordx4 v[40:43], v6, s[32:35], 0 offen nt
 s_branch L_k3
L_k4_late:
 s_cmp_ge_u32 s3, 3
 s_waitcnt vmcnt(8)
 s_cbranch_scc1 L_k4_far
 s_waitcnt vmcnt(7)
L_k4_far:
 buffer_load_dwordx4 v[44:47], v6, s[32:35], 0 offen nt
 s_branch L_k4
L_k5_late:
 s_cmp_ge_u32 s3, 3
 s_waitcnt vmcnt(8)
 s_cbranch_scc1 L_k5_far
 s_waitcnt vmcnt(7)
L_k5_far:
 buffer_load_dwordx4 v[48:51], v6, s[32:35], 0 offen nt
 s_branch L_k5
L_k6_late:
 s_cmp_ge_u32 s3, 3
 s_waitcnt vmcnt(8)
 s_cbranch_scc1 L_k6_far
 s_waitcnt vmcnt(7)
L_k6_far:
 buffer_load_dwordx4 v[52:55], v6, s[32:35], 0 offen nt
 s_branch L_k6
L_k7_late:
 s_cmp_ge_u32 s3, 3
 s_waitcnt vmcnt(8)
 s_cbranch_scc1 L_k7_far
 s_waitcnt vmcnt(5)
L_k7_far:
 buffer_load_dwordx4 v[56:59], v6, s[32:35], 0 offen nt
 s_branch L_k7
L_v0_0_late:
 s_cmp_ge_u32 s3, 3
 s_waitcnt vmcnt(6)
 s_cbranch_scc1 L_v0_0_far
 s_waitcnt vmcnt(5)
L_v0_0_far:
 buffer_load_dwordx4 v[60:63], v6, s[32:35], 0 offen nt
 s_branch L_v0_0
L_v0_1_late:
 s_cmp_ge_u32 s3, 3
 s_waitcnt vmcnt(6)
 s_cbranch_scc1 L_v0_1_far
 s_waitcnt vmcnt(5)
L_v0_1_far:
 buffer_load_dwordx4 v[32:35], v6, s[32:35], 0 offen nt
 s_branch L_v0_1
L_v0_2_late:
 s_cmp_ge_u32 s3, 3
 s_waitcnt vmcnt(8)
 s_cbranch_scc1 L_v0_2_far
 s_waitcnt vmcnt(7)
L_v0_2_far:
 buffer_load_dwordx4 v[36:39], v6, s[32:35], 0 offen nt
 s_branch L_v0_2
L_v0_3_late:
 s_cmp_ge_u32 s3, 3
 s_waitcnt vmcnt(8)
 s_cbranch_scc1 L_v0_3_far
 s_waitcnt vmcnt(7)
L_v0_3_far:
 buffer_load_dwordx4 v[40:43], v6, s[32:35], 0 offen nt
 s_branch L_v0_3
L_v0_4_late:
 s_cmp_ge_u32 s3, 3
 s_waitcnt vmcnt(8)
 s_cbranch_scc1 L_v0_4_far
 s_waitcnt vmcnt(7)
L_v0_4_far:
 buffer_load_dwordx4 v[44:47], v6, s[32:35], 0 offen nt
 s_branch L_v0_4
L_v0_5_late:
 s_cmp_ge_u32 s3, 3
 s_waitcnt vmcnt(8)
 s_cbranch_scc1 L_v0_5_far
 s_waitcnt vmcnt(7)
L_v0_5_far:
 buffer_load_dwordx4 v[48:51], v6, s[32:35], 0 offen nt
 s_branch L_v0_5
L_v0_6_late:
 s_cmp_ge_u32 s3, 3
 s_waitcnt vmcnt(8)
 s_cbranch_scc1 L_v0_6_far
 s_waitcnt vmcnt(7)
L_v0_6_far:
 buffer_load_dwordx4 v[52:55], v6, s[32:35], 0 offen nt
 s_branch L_v0_6
L_v0_7_late:
 s_cmp_ge_u32 s3, 3
 s_waitcnt vmcnt(8)
 s_cbranch_scc1 L_v0_7_far
 s_waitcnt vmcnt(5)
L_v0_7_far:
 buffer_load_dwordx4 v[56:59], v6, s[32:35], 0 offen nt
 s_branch L_v0_7
L_last:
 s_nop 1
 v_add_f32_dpp v24, v24, v24 row_half_mirror row_mask:0xf bank_mask:0xf
 s_nop 1
 v_add_f32_dpp v24, v24, v24 row_mirror row_mask:0xf bank_mask:0xf
 s_nop 1
 v_add_f32_dpp v24, v24, v24 row_bcast:15 row_mask:0xa bank_mask:0xf
 s_nop 1
 v_add_f32_dpp v24, v24, v24 row_bcast:31 row_mask:0xc bank_mask:0xf
 v_mov_b32 v30, s68
 v_readlane_b32 s71, v24, 63
 v_mov_b32 v0, s60
 v_lshlrev_b32 v0, 3, v0
 v_mov_b32 v31, s71
 ds_write_b64 v0, v[30:31] offset:8192
 s_waitcnt lgkmcnt(0)
 s_barrier
 v_and_b32_dpp v72, v25, v8 row_newbcast:8 row_mask:0xf bank_mask:0xf
 v_and_b32_dpp v73, v25, v9 row_newbcast:8 row_mask:0xf bank_mask:0xf
 v_and_b32_dpp v74, v25, v10 row_newbcast:8 row_mask:0xf bank_mask:0xf
 v_and_b32_dpp v75, v25, v11 row_newbcast:8 row_mask:0xf bank_mask:0xf
 v_and_b32_dpp v76, v25, v8 row_newbcast:12 row_mask:0xf bank_mask:0xf
 v_and_b32_dpp v77, v25, v9 row_newbcast:12 row_mask:0xf bank_mask:0xf
 v_and_b32_dpp v78, v25, v10 row_newbcast:12 row_mask:0xf bank_mask:0xf
 v_and_b32_dpp v79, v25, v11 row_newbcast:12 row_mask:0xf bank_mask:0xf
 v_and_b32_dpp v80, v26, v8 row_newbcast:0 row_mask:0xf bank_mask:0xf
 v_and_b32_dpp v81, v26, v9 row_newbcast:0 row_mask:0xf bank_mask:0xf
 v_and_b32_dpp v82, v26, v10 row_newbcast:0 row_mask:0xf bank_mask:0xf
 v_and_b32_dpp v83, v26, v11 row_newbcast:0 row_mask:0xf bank_mask:0xf
 v_and_b32_dpp v84, v26, v8 row_newbcast:4 row_mask:0xf bank_mask:0xf
 v_and_b32_dpp v85, v26, v9 row_newbcast:4 row_mask:0xf bank_mask:0xf
 v_and_b32_dpp v86, v26, v10 row_newbcast:4 row_mask:0xf bank_mask:0xf
 v_and_b32_dpp v87, v26, v11 row_newbcast:4 row_mask:0xf bank_mask:0xf
 v_and_b32_dpp v88, v26, v8 row_newbcast:8 row_mask:0xf bank_mask:0xf
 v_and_b32_dpp v89, v26, v9 row_newbcast:8 row_mask:0xf bank_mask:0xf
 v_and_b32_dpp v90, v26, v10 row_newbcast:8 row_mask:0xf bank_mask:0xf
 v_and_b32_dpp v91, v26, v11 row_newbcast:8 row_mask:0xf bank_mask:0xf
 v_and_b32_dpp v92, v26, v8 row_newbcast:12 row_mask:0xf bank_mask:0xf
 v_and_b32_dpp v93, v26, v9 row_newbcast:12 row_mask:0xf bank_mask:0xf
 v_and_b32_dpp v94, v26, v10 row_newbcast:12 row_mask:0xf bank_mask:0xf
 v_and_b32_dpp v95, v26, v11 row_newbcast:12 row_mask:0xf bank_mask:0xf
 s_waitcnt vmcnt(6)
 v_mfma_f32_16x16x32_bf16 v[12:15], v[20:23], v[36:39], v[12:15]
 s_waitcnt vmcnt(5)
 v_mfma_f32_16x16x32_bf16 v[12:15], v[72:75], v[40:43], v[12:15]
 s_waitcnt vmcnt(4)
 v_mfma_f32_16x16x32_bf16 v[12:15], v[76:79], v[44:47], v[12:15]
 s_waitcnt vmcnt(3)
 v_mfma_f32_16x16x32_bf16 v[12:15], v[80:83], v[48:51], v[12:15]
 s_waitcnt vmcnt(2)
 v_mfma_f32_16x16x32_bf16 v[12:15], v[84:87], v[52:55], v[12:15]
 s_waitcnt vmcnt(1)
 v_mfma_f32_16x16x32_bf16 v[12:15], v[88:91], v[56:59], v[12:15]
 s_waitcnt vmcnt(0)
 v_mfma_f32_16x16x32_bf16 v[12:15], v[92:95], v[60:63], v[12:15]
 s_nop 7
 v_cvt_pk_bf16_f32 v28, v12, v13
 v_cvt_pk_bf16_f32 v29, v14, v15
 ds_write_b64 v3, v[28:29] offset:2048
 s_waitcnt lgkmcnt(0)
 s_barrier
 s_endpgm
L_aux:
 s_lshr_b32 s61, s78, 6
 s_and_b32 s63, s78, 63
 s_lshr_b32 s62, s63, 1
 s_mov_b32 s42, 0x400000
 s_mov_b32 s43, 0x00020000
 v_and_b32 v35, 0x300, v31
 v_and_b32 v34, 0xf0, v31
 v_lshl_or_b32 v75, v35, 10, v34
 v_lshl_or_b32 v76, v35, 7, v34
 s_lshl_b32 s72, s61, 10
 v_add_u32 v32, s72, v31
 s_lshl_b32 s73, s60, 8
 s_add_u32 s72, s72, s73
 s_and_b32 s74, s78, 1
 s_lshl1_add_u32 s74, s61, s74
 s_lshl_b32 s73, s74, 1
 v_xor_b32 v33, s73, v30
 v_lshl_add_u32 v33, v33, 2, s72
 s_lshl_b32 s65, s60, 20
 s_lshl_b32 s72, s62, 8
 s_add_u32 s65, s65, s72
 s_lshl_b32 s72, s74, 15
 s_add_u32 s65, s65, s72
 s_lshl_b32 s71, s61, 17
 s_lshl_b32 s73, s63, 8
 s_add_u32 s71, s71, s73
 v_lshl_or_b32 v41, v35, 6, v34
 v_add_u32 v41, s71, v41
 v_add_u32 v45, 0x10000, v41
 s_lshl_b32 s71, s78, 7
 s_add_u32 s71, s71, 524288
 v_mov_b32 v92, s71
 v_mov_b32 v36, -1
 v_mov_b32 v37, -1
 v_mov_b32 v38, -1
 v_mov_b32 v39, -1
 s_waitcnt lgkmcnt(0)
 s_cmp_lg_u32 s60, 0
 s_cbranch_scc1 L_nc
 global_store_dwordx4 v41, v[36:39], s[6:7] sc1
 global_store_dwordx4 v45, v[36:39], s[6:7] sc1
 s_mov_b64 exec, 1
 global_store_dwordx2 v92, v[36:37], s[6:7] sc1
 s_mov_b64 exec, -1
 s_cmp_ge_u32 s2, 8
 s_cbranch_scc1 L_nc
 s_lshl_b32 s71, s2, 10
 s_add_u32 s71, s71, 589824
 v_add_u32 v116, s71, v31
 v_mov_b32 v120, 0
 v_mov_b32 v121, 0
 v_mov_b32 v122, 0
 v_mov_b32 v123, 0
 v_add_u32 v117, 8192, v116
 s_getreg_b32 s71, hwreg(HW_REG_XCC_ID, 0, 1)
 s_mul_i32 s71, s71, 14
 s_add_u32 s71, s71, 85
 v_writelane_b32 v120, s71, 32
 global_store_dwordx4 v116, v[120:123], s[6:7] sc1
 s_mov_b64 exec, 0xff
 global_store_dwordx4 v117, v[120:123], s[6:7] sc1
 s_mov_b64 exec, -1
L_nc:
 global_load_dwordx4 v[48:51], v32, s[4:5]
 global_load_dword v52, v33, s[4:5]
 s_xor_b32 s64, s65, 0
 buffer_load_dwordx4 v[128:131], v75, s[40:43], s64 offen
 s_xor_b32 s64, s65, 8192
 buffer_load_dwordx4 v[132:135], v75, s[40:43], s64 offen
 s_xor_b32 s64, s65, 16384
 buffer_load_dwordx4 v[136:139], v75, s[40:43], s64 offen
 s_xor_b32 s64, s65, 24576
 buffer_load_dwordx4 v[140:143], v75, s[40:43], s64 offen
 s_xor_b32 s64, s65, 32768
 buffer_load_dwordx4 v[144:147], v75, s[40:43], s64 offen
 s_xor_b32 s64, s65, 40960
 buffer_load_dwordx4 v[148:151], v75, s[40:43], s64 offen
 s_xor_b32 s64, s65, 49152
 buffer_load_dwordx4 v[152:155], v75, s[40:43], s64 offen
 s_xor_b32 s64, s65, 57344
 buffer_load_dwordx4 v[156:159], v75, s[40:43], s64 offen
 s_lshl_b32 s71, s61, 17
 s_lshl_b32 s72, s60, 15
 s_add_u32 s71, s71, s72
 s_lshl_b32 s72, s63, 8
 s_add_u32 s71, s71, s72
 v_and_b32 v65, 0x70, v31
 v_and_b32 v35, 16, v30
 v_lshl_or_b32 v65, v35, 3, v65
 v_and_b32 v35, 8, v30
 v_lshl_or_b32 v65, v35, 11, v65
 v_add_u32 v65, s71, v65
 s_lshr_b32 s71, s78, 3
 s_and_b32 s72, s78, 7
 s_and_b32 s73, s72, 3
 s_lshl2_add_u32 s77, s71, s73
 s_lshr_b32 s73, s60, 1
 s_lshl1_add_u32 s77, s77, s73
 s_lshr_b32 s73, s72, 2
 s_lshl1_add_u32 s77, s77, s73
 s_and_b32 s73, s60, 1
 s_lshl1_add_u32 s77, s77, s73
 s_lshl_b32 s77, s77, 2
 s_lshl2_add_u32 s71, s71, s60
 s_lshl_b32 s71, s71, 12
 s_lshl_b32 s72, s72, 5
 s_add_u32 s71, s71, s72
 v_lshrrev_b32 v66, 2, v30
 v_lshlrev_b32 v66, 8, v66
 v_and_b32 v35, 3, v30
 v_lshl_or_b32 v66, v35, 3, v66
 v_add_u32 v66, s71, v66
 s_lshl_b32 s72, s61, 13
 s_add_u32 s72, s72, 524288
 v_lshl_add_u32 v67, v30, 7, s72
 v_mov_b32 v34, s77
 v_mov_b32 v72, 0
 global_load_dword v53, v34, s[4:5]
 global_load_ushort v54, v72, s[18:19]
 v_and_b32 v42, 15, v30
 v_and_b32 v43, 1, v30
 v_lshlrev_b32 v43, 4, v43
 v_mov_b32 v44, 0xffff
 v_lshlrev_b32 v44, v43, v44
 v_lshrrev_b32 v45, 1, v42
 v_cmp_eq_u32 vcc, 0, v45
 s_nop 1
 v_cndmask_b32 v8, 0, v44, vcc
 v_cmp_eq_u32 vcc, 1, v45
 s_nop 1
 v_cndmask_b32 v9, 0, v44, vcc
 v_cmp_eq_u32 vcc, 2, v45
 s_nop 1
 v_cndmask_b32 v10, 0, v44, vcc
 v_cmp_eq_u32 vcc, 3, v45
 s_nop 1
 v_cndmask_b32 v11, 0, v44, vcc
 v_lshlrev_b32 v3, 5, v42
 v_and_b32 v43, 16, v30
 v_or_b32 v3, v3, v43
 v_and_b32 v43, 32, v30
 v_lshl_or_b32 v3, v43, 7, v3
 s_lshl_b32 s71, s60, 9
 v_add_u32 v3, s71, v3
 s_mov_b32 s70, 0x3fb8aa3b
 s_lshl_b32 s71, s61, 6
 v_mov_b32 v77, s71
 s_waitcnt vmcnt(10)
 s_cmp_lg_u32 s60, 0
 s_cbranch_scc1 L_nosig
 v_mov_b32 v43, 1
 s_mov_b64 exec, 1
 global_atomic_add v77, v43, s[22:23] sc1
 s_mov_b64 exec, -1
L_nosig:
 s_lshr_b32 s72, s2, 3
 s_lshl2_add_u32 s72, s72, s60
 s_cmp_ge_u32 s72, 2
 s_cbranch_scc1 L_nowarm
 s_getpc_b64 s[24:25]
L_pc:
 s_sub_u32 s24, s24, L_pc-parallel_sum__gqa_block_cached__mixer_token_mlp__decode_kernel
 s_subb_u32 s25, s25, 0
 s_lshl_b32 s71, s60, 13
 v_lshl_add_u32 v44, v30, 7, s71
 v_min_u32 v44, L_codeend-parallel_sum__gqa_block_cached__mixer_token_mlp__decode_kernel-4, v44
 global_load_dword v112, v44, s[24:25]
L_nowarm:
 s_cmp_lg_u32 s72, 7
 s_cbranch_scc1 L_nompf
 v_lshlrev_b32 v44, 7, v30
 v_min_u32 v44, 2748, v44
 global_load_dword v124, v44, s[12:13]
 global_load_dword v125, v44, s[14:15]
 global_load_dword v126, v44, s[16:17]
L_nompf:
 v_lshlrev_b32 v56, 16, v48
 v_and_b32 v57, 0xffff0000, v48
 v_lshlrev_b32 v58, 16, v49
 v_and_b32 v59, 0xffff0000, v49
 v_lshlrev_b32 v60, 16, v50
 v_and_b32 v61, 0xffff0000, v50
 v_lshlrev_b32 v62, 16, v51
 v_and_b32 v63, 0xffff0000, v51
 v_add_f32 v32, v56, v57
 v_add_f32 v33, v58, v59
 v_add_f32 v34, v60, v61
 v_add_f32 v35, v62, v63
 v_add_f32 v32, v32, v33
 v_add_f32 v34, v34, v35
 v_add_f32 v32, v32, v34
 s_nop 1
 v_add_f32_dpp v32, v32, v32 quad_perm:[1,0,3,2] row_mask:0xf bank_mask:0xf
 s_nop 1
 v_add_f32_dpp v32, v32, v32 quad_perm:[2,3,0,1] row_mask:0xf bank_mask:0xf
 s_nop 1
 v_add_f32_dpp v32, v32, v32 row_half_mirror row_mask:0xf bank_mask:0xf
 s_nop 1
 v_add_f32_dpp v32, v32, v32 row_mirror row_mask:0xf bank_mask:0xf
 s_nop 1
 v_add_f32_dpp v32, v32, v32 row_bcast:15 row_mask:0xa bank_mask:0xf
 s_nop 1
 v_add_f32_dpp v32, v32, v32 row_bcast:31 row_mask:0xc bank_mask:0xf
 v_mul_f32 v32, 0x3b000000, v32
 s_nop 0
 v_readlane_b32 s71, v32, 63
 v_cvt_pk_bf16_f32 v41, v32, v32
 v_and_b32 v41, 0xffff0000, v41
 v_subrev_f32 v33, s71, v56
 v_subrev_f32 v34, s71, v57
 v_subrev_f32 v35, s71, v58
 v_subrev_f32 v36, s71, v59
 v_subrev_f32 v37, s71, v60
 v_subrev_f32 v38, s71, v61
 v_subrev_f32 v39, s71, v62
 v_subrev_f32 v40, s71, v63
 v_readlane_b32 s75, v41, 63
 v_mul_f32 v32, v33, v33
 v_fmac_f32 v32, v34, v34
 v_fmac_f32 v32, v35, v35
 v_fmac_f32 v32, v36, v36
 v_fmac_f32 v32, v37, v37
 v_fmac_f32 v32, v38, v38
 v_fmac_f32 v32, v39, v39
 v_fmac_f32 v32, v40, v40
 s_nop 1
 v_add_f32_dpp v32, v32, v32 quad_perm:[1,0,3,2] row_mask:0xf bank_mask:0xf
 s_nop 1
 v_add_f32_dpp v32, v32, v32 quad_perm:[2,3,0,1] row_mask:0xf bank_mask:0xf
 s_nop 1
 v_add_f32_dpp v32, v32, v32 row_half_mirror row_mask:0xf bank_mask:0xf
 s_nop 1
 v_add_f32_dpp v32, v32, v32 row_mirror row_mask:0xf bank_mask:0xf
 s_nop 1
 v_add_f32_dpp v32, v32, v32 row_bcast:15 row_mask:0xa bank_mask:0xf
 s_nop 1
 v_add_f32_dpp v32, v32, v32 row_bcast:31 row_mask:0xc bank_mask:0xf
 v_mul_f32 v32, 0x3b000000, v32
 v_cvt_pk_bf16_f32 v32, v32, v32
 v_and_b32 v32, 0xffff0000, v32
 v_add_f32 v32, 0x3727c5ac, v32
 v_cvt_pk_bf16_f32 v32, v32, v32
 v_and_b32 v32, 0xffff0000, v32
 v_sqrt_f32 v32, v32
 s_nop 0
 v_cvt_pk_bf16_f32 v32, v32, v32
 v_and_b32 v32, 0xffff0000, v32
 v_rcp_f32 v32, v32
 s_nop 1
 v_readlane_b32 s76, v32, 63
 s_nop 1
 v_lshlrev_b32 v25, 16, v52
 v_and_b32 v26, 0xffff0000, v52
 v_subrev_f32 v25, s75, v25
 v_subrev_f32 v26, s75, v26
 v_cvt_pk_bf16_f32 v0, v25, v26
 v_lshlrev_b32 v25, 16, v0
 v_and_b32 v26, 0xffff0000, v0
 v_mul_f32 v25, s76, v25
 v_mul_f32 v26, s76, v26
 v_cvt_pk_bf16_f32 v0, v25, v26
 v_lshlrev_b32 v25, 16, v0
 v_and_b32 v26, 0xffff0000, v0
 v_cvt_pk_bf16_f32 v25, v25, v25
 v_cvt_pk_bf16_f32 v26, v26, v26
 s_xor_b32 s64, s65, 65536
 s_waitcnt vmcnt(3)
 buffer_load_dwordx4 v[160:163], v75, s[40:43], s64 offen
 s_xor_b32 s64, s65, 73728
 s_waitcnt vmcnt(3)
 buffer_load_dwordx4 v[164:167], v75, s[40:43], s64 offen
 s_xor_b32 s64, s65, 81920
 s_waitcnt vmcnt(3)
 buffer_load_dwordx4 v[168:171], v75, s[40:43], s64 offen
 s_xor_b32 s64, s65, 90112
 s_waitcnt vmcnt(3)
 buffer_load_dwordx4 v[172:175], v75, s[40:43], s64 offen
 s_xor_b32 s64, s65, 98304
 s_waitcnt vmcnt(3)
 buffer_load_dwordx4 v[176:179], v75, s[40:43], s64 offen
 s_xor_b32 s64, s65, 106496
 s_waitcnt vmcnt(3)
 buffer_load_dwordx4 v[180:183], v75, s[40:43], s64 offen
 s_xor_b32 s64, s65, 114688
 s_waitcnt vmcnt(3)
 buffer_load_dwordx4 v[184:187], v75, s[40:43], s64 offen
 s_xor_b32 s64, s65, 122880
 s_waitcnt vmcnt(3)
 buffer_load_dwordx4 v[188:191], v75, s[40:43], s64 offen
 s_xor_b32 s64, s65, 131072
 s_waitcnt vmcnt(3)
 buffer_load_dwordx4 v[192:195], v75, s[40:43], s64 offen
 s_xor_b32 s64, s65, 139264
 s_waitcnt vmcnt(3)
 buffer_load_dwordx4 v[196:199], v75, s[40:43], s64 offen
 s_xor_b32 s64, s65, 147456
 s_waitcnt vmcnt(3)
 buffer_load_dwordx4 v[200:203], v75, s[40:43], s64 offen
 s_xor_b32 s64, s65, 155648
 s_waitcnt vmcnt(3)
 buffer_load_dwordx4 v[204:207], v75, s[40:43], s64 offen
 s_xor_b32 s64, s65, 163840
 s_waitcnt vmcnt(3)
 buffer_load_dwordx4 v[208:211], v75, s[40:43], s64 offen
 s_xor_b32 s64, s65, 172032
 s_waitcnt vmcnt(3)
 buffer_load_dwordx4 v[212:215], v75, s[40:43], s64 offen
 s_xor_b32 s64, s65, 180224
 s_waitcnt vmcnt(3)
 buffer_load_dwordx4 v[216:219], v75, s[40:43], s64 offen
 s_xor_b32 s64, s65, 188416
 s_waitcnt vmcnt(3)
 buffer_load_dwordx4 v[220:223], v75, s[40:43], s64 offen
 s_xor_b32 s64, s65, 196608
 s_waitcnt vmcnt(3)
 buffer_load_dwordx4 v[224:227], v75, s[40:43], s64 offen
 s_xor_b32 s64, s65, 204800
 s_waitcnt vmcnt(3)
 buffer_load_dwordx4 v[228:231], v75, s[40:43], s64 offen
 s_xor_b32 s64, s65, 212992
 s_waitcnt vmcnt(3)
 buffer_load_dwordx4 v[232:235], v75, s[40:43], s64 offen
 s_xor_b32 s64, s65, 221184
 s_waitcnt vmcnt(3)
 buffer_load_dwordx4 v[236:239], v75, s[40:43], s64 offen
 s_xor_b32 s64, s65, 229376
 s_waitcnt vmcnt(3)
 buffer_load_dwordx4 v[240:243], v75, s[40:43], s64 offen
 s_xor_b32 s64, s65, 237568
 s_waitcnt vmcnt(3)
 buffer_load_dwordx4 v[244:247], v75, s[40:43], s64 offen
 s_xor_b32 s64, s65, 245760
 s_waitcnt vmcnt(3)
 buffer_load_dwordx4 v[248:251], v75, s[40:43], s64 offen
 s_xor_b32 s64, s65, 253952
 s_waitcnt vmcnt(3)
 buffer_load_dwordx4 v[252:255], v75, s[40:43], s64 offen
 v_and_b32_dpp v16, v25, v8 row_newbcast:0 row_mask:0xf bank_mask:0xf
 v_and_b32_dpp v17, v25, v9 row_newbcast:0 row_mask:0xf bank_mask:0xf
 v_and_b32_dpp v18, v25, v10 row_newbcast:0 row_mask:0xf bank_mask:0xf
 v_and_b32_dpp v19, v25, v11 row_newbcast:0 row_mask:0xf bank_mask:0xf
 v_and_b32_dpp v20, v26, v8 row_newbcast:0 row_mask:0xf bank_mask:0xf
 v_and_b32_dpp v21, v26, v9 row_newbcast:0 row_mask:0xf bank_mask:0xf
 v_and_b32_dpp v22, v26, v10 row_newbcast:0 row_mask:0xf bank_mask:0xf
 v_and_b32_dpp v23, v26, v11 row_newbcast:0 row_mask:0xf bank_mask:0xf
 s_waitcnt vmcnt(4)
 v_mfma_f32_16x16x32_bf16 v[12:15], v[16:19], v[128:131], 0
 v_and_b32_dpp v16, v25, v8 row_newbcast:1 row_mask:0xf bank_mask:0xf
 v_and_b32_dpp v17, v25, v9 row_newbcast:1 row_mask:0xf bank_mask:0xf
 v_and_b32_dpp v18, v25, v10 row_newbcast:1 row_mask:0xf bank_mask:0xf
 v_and_b32_dpp v19, v25, v11 row_newbcast:1 row_mask:0xf bank_mask:0xf
 v_mfma_f32_16x16x32_bf16 v[12:15], v[20:23], v[132:135], v[12:15]
 v_and_b32_dpp v20, v26, v8 row_newbcast:1 row_mask:0xf bank_mask:0xf
 v_and_b32_dpp v21, v26, v9 row_newbcast:1 row_mask:0xf bank_mask:0xf
 v_and_b32_dpp v22, v26, v10 row_newbcast:1 row_mask:0xf bank_mask:0xf
 v_and_b32_dpp v23, v26, v11 row_newbcast:1 row_mask:0xf bank_mask:0xf
 v_mfma_f32_16x16x32_bf16 v[12:15], v[16:19], v[136:139], v[12:15]
 v_and_b32_dpp v16, v25, v8 row_newbcast:2 row_mask:0xf bank_mask:0xf
 v_and_b32_dpp v17, v25, v9 row_newbcast:2 row_mask:0xf bank_mask:0xf
 v_and_b32_dpp v18, v25, v10 row_newbcast:2 row_mask:0xf bank_mask:0xf
 v_and_b32_dpp v19, v25, v11 row_newbcast:2 row_mask:0xf bank_mask:0xf
 v_mfma_f32_16x16x32_bf16 v[12:15], v[20:23], v[140:143], v[12:15]
 v_and_b32_dpp v20, v26, v8 row_newbcast:2 row_mask:0xf bank_mask:0xf
 v_and_b32_dpp v21, v26, v9 row_newbcast:2 row_mask:0xf bank_mask:0xf
 v_and_b32_dpp v22, v26, v10 row_newbcast:2 row_mask:0xf bank_mask:0xf
 v_and_b32_dpp v23, v26, v11 row_newbcast:2 row_mask:0xf bank_mask:0xf
 v_mfma_f32_16x16x32_bf16 v[12:15], v[16:19], v[144:147], v[12:15]
 v_and_b32_dpp v16, v25, v8 row_newbcast:3 row_mask:0xf bank_mask:0xf
 v_and_b32_dpp v17, v25, v9 row_newbcast:3 row_mask:0xf bank_mask:0xf
 v_and_b32_dpp v18, v25, v10 row_newbcast:3 row_mask:0xf bank_mask:0xf
 v_and_b32_dpp v19, v25, v11 row_newbcast:3 row_mask:0xf bank_mask:0xf
 v_mfma_f32_16x16x32_bf16 v[12:15], v[20:23], v[148:151], v[12:15]
 v_and_b32_dpp v20, v26, v8 row_newbcast:3 row_mask:0xf bank_mask:0xf
 v_and_b32_dpp v21, v26, v9 row_newbcast:3 row_mask:0xf bank_mask:0xf
 v_and_b32_dpp v22, v26, v10 row_newbcast:3 row_mask:0xf bank_mask:0xf
 v_and_b32_dpp v23, v26, v11 row_newbcast:3 row_mask:0xf bank_mask:0xf
 v_mfma_f32_16x16x32_bf16 v[12:15], v[16:19], v[152:155], v[12:15]
 v_and_b32_dpp v16, v25, v8 row_newbcast:4 row_mask:0xf bank_mask:0xf
 v_and_b32_dpp v17, v25, v9 row_newbcast:4 row_mask:0xf bank_mask:0xf
 v_and_b32_dpp v18, v25, v10 row_newbcast:4 row_mask:0xf bank_mask:0xf
 v_and_b32_dpp v19, v25, v11 row_newbcast:4 row_mask:0xf bank_mask:0xf
 v_mfma_f32_16x16x32_bf16 v[12:15], v[20:23], v[156:159], v[12:15]
 v_and_b32_dpp v20, v26, v8 row_newbcast:4 row_mask:0xf bank_mask:0xf
 v_and_b32_dpp v21, v26, v9 row_newbcast:4 row_mask:0xf bank_mask:0xf
 v_and_b32_dpp v22, v26, v10 row_newbcast:4 row_mask:0xf bank_mask:0xf
 v_and_b32_dpp v23, v26, v11 row_newbcast:4 row_mask:0xf bank_mask:0xf
 v_mfma_f32_16x16x32_bf16 v[12:15], v[16:19], v[160:163], v[12:15]
 v_and_b32_dpp v16, v25, v8 row_newbcast:5 row_mask:0xf bank_mask:0xf
 v_and_b32_dpp v17, v25, v9 row_newbcast:5 row_mask:0xf bank_mask:0xf
 v_and_b32_dpp v18, v25, v10 row_newbcast:5 row_mask:0xf bank_mask:0xf
 v_and_b32_dpp v19, v25, v11 row_newbcast:5 row_mask:0xf bank_mask:0xf
 v_mfma_f32_16x16x32_bf16 v[12:15], v[20:23], v[164:167], v[12:15]
 v_and_b32_dpp v20, v26, v8 row_newbcast:5 row_mask:0xf bank_mask:0xf
 v_and_b32_dpp v21, v26, v9 row_newbcast:5 row_mask:0xf bank_mask:0xf
 v_and_b32_dpp v22, v26, v10 row_newbcast:5 row_mask:0xf bank_mask:0xf
 v_and_b32_dpp v23, v26, v11 row_newbcast:5 row_mask:0xf bank_mask:0xf
 v_mfma_f32_16x16x32_bf16 v[12:15], v[16:19], v[168:171], v[12:15]
 v_and_b32_dpp v16, v25, v8 row_newbcast:6 row_mask:0xf bank_mask:0xf
 v_and_b32_dpp v17, v25, v9 row_newbcast:6 row_mask:0xf bank_mask:0xf
 v_and_b32_dpp v18, v25, v10 row_newbcast:6 row_mask:0xf bank_mask:0xf
 v_and_b32_dpp v19, v25, v11 row_newbcast:6 row_mask:0xf bank_mask:0xf
 v_mfma_f32_16x16x32_bf16 v[12:15], v[20:23], v[172:175], v[12:15]
 v_and_b32_dpp v20, v26, v8 row_newbcast:6 row_mask:0xf bank_mask:0xf
 v_and_b32_dpp v21, v26, v9 row_newbcast:6 row_mask:0xf bank_mask:0xf
 v_and_b32_dpp v22, v26, v10 row_newbcast:6 row_mask:0xf bank_mask:0xf
 v_and_b32_dpp v23, v26, v11 row_newbcast:6 row_mask:0xf bank_mask:0xf
 v_mfma_f32_16x16x32_bf16 v[12:15], v[16:19], v[176:179], v[12:15]
 v_and_b32_dpp v16, v25, v8 row_newbcast:7 row_mask:0xf bank_mask:0xf
 v_and_b32_dpp v17, v25, v9 row_newbcast:7 row_mask:0xf bank_mask:0xf
 v_and_b32_dpp v18, v25, v10 row_newbcast:7 row_mask:0xf bank_mask:0xf
 v_and_b32_dpp v19, v25, v11 row_newbcast:7 row_mask:0xf bank_mask:0xf
 v_mfma_f32_16x16x32_bf16 v[12:15], v[20:23], v[180:183], v[12:15]
 v_and_b32_dpp v20, v26, v8 row_newbcast:7 row_mask:0xf bank_mask:0xf
 v_and_b32_dpp v21, v26, v9 row_newbcast:7 row_mask:0xf bank_mask:0xf
 v_and_b32_dpp v22, v26, v10 row_newbcast:7 row_mask:0xf bank_mask:0xf
 v_and_b32_dpp v23, v26, v11 row_newbcast:7 row_mask:0xf bank_mask:0xf
 v_mfma_f32_16x16x32_bf16 v[12:15], v[16:19], v[184:187], v[12:15]
 v_and_b32_dpp v16, v25, v8 row_newbcast:8 row_mask:0xf bank_mask:0xf
 v_and_b32_dpp v17, v25, v9 row_newbcast:8 row_mask:0xf bank_mask:0xf
 v_and_b32_dpp v18, v25, v10 row_newbcast:8 row_mask:0xf bank_mask:0xf
 v_and_b32_dpp v19, v25, v11 row_newbcast:8 row_mask:0xf bank_mask:0xf
 v_mfma_f32_16x16x32_bf16 v[12:15], v[20:23], v[188:191], v[12:15]
 v_and_b32_dpp v20, v26, v8 row_newbcast:8 row_mask:0xf bank_mask:0xf
 v_and_b32_dpp v21, v26, v9 row_newbcast:8 row_mask:0xf bank_mask:0xf
 v_and_b32_dpp v22, v26, v10 row_newbcast:8 row_mask:0xf bank_mask:0xf
 v_and_b32_dpp v23, v26, v11 row_newbcast:8 row_mask:0xf bank_mask:0xf
 v_mfma_f32_16x16x32_bf16 v[12:15], v[16:19], v[192:195], v[12:15]
 v_and_b32_dpp v16, v25, v8 row_newbcast:9 row_mask:0xf bank_mask:0xf
 v_and_b32_dpp v17, v25, v9 row_newbcast:9 row_mask:0xf bank_mask:0xf
 v_and_b32_dpp v18, v25, v10 row_newbcast:9 row_mask:0xf bank_mask:0xf
 v_and_b32_dpp v19, v25, v11 row_newbcast:9 row_mask:0xf bank_mask:0xf
 v_mfma_f32_16x16x32_bf16 v[12:15], v[20:23], v[196:199], v[12:15]
 v_and_b32_dpp v20, v26, v8 row_newbcast:9 row_mask:0xf bank_mask:0xf
 v_and_b32_dpp v21, v26, v9 row_newbcast:9 row_mask:0xf bank_mask:0xf
 v_and_b32_dpp v22, v26, v10 row_newbcast:9 row_mask:0xf bank_mask:0xf
 v_and_b32_dpp v23, v26, v11 row_newbcast:9 row_mask:0xf bank_mask:0xf
 v_mfma_f32_16x16x32_bf16 v[12:15], v[16:19], v[200:203], v[12:15]
 v_and_b32_dpp v16, v25, v8 row_newbcast:10 row_mask:0xf bank_mask:0xf
 v_and_b32_dpp v17, v25, v9 row_newbcast:10 row_mask:0xf bank_mask:0xf
 v_and_b32_dpp v18, v25, v10 row_newbcast:10 row_mask:0xf bank_mask:0xf
 v_and_b32_dpp v19, v25, v11 row_newbcast:10 row_mask:0xf bank_mask:0xf
 v_mfma_f32_16x16x32_bf16 v[12:15], v[20:23], v[204:207], v[12:15]
 v_and_b32_dpp v20, v26, v8 row_newbcast:10 row_mask:0xf bank_mask:0xf
 v_and_b32_dpp v21, v26, v9 row_newbcast:10 row_mask:0xf bank_mask:0xf
 v_and_b32_dpp v22, v26, v10 row_newbcast:10 row_mask:0xf bank_mask:0xf
 v_and_b32_dpp v23, v26, v11 row_newbcast:10 row_mask:0xf bank_mask:0xf
 v_mfma_f32_16x16x32_bf16 v[12:15], v[16:19], v[208:211], v[12:15]
 v_and_b32_dpp v16, v25, v8 row_newbcast:11 row_mask:0xf bank_mask:0xf
 v_and_b32_dpp v17, v25, v9 row_newbcast:11 row_mask:0xf bank_mask:0xf
 v_and_b32_dpp v18, v25, v10 row_newbcast:11 row_mask:0xf bank_mask:0xf
 v_and_b32_dpp v19, v25, v11 row_newbcast:11 row_mask:0xf bank_mask:0xf
 v_mfma_f32_16x16x32_bf16 v[12:15], v[20:23], v[212:215], v[12:15]
 v_and_b32_dpp v20, v26, v8 row_newbcast:11 row_mask:0xf bank_mask:0xf
 v_and_b32_dpp v21, v26, v9 row_newbcast:11 row_mask:0xf bank_mask:0xf
 v_and_b32_dpp v22, v26, v10 row_newbcast:11 row_mask:0xf bank_mask:0xf
 v_and_b32_dpp v23, v26, v11 row_newbcast:11 row_mask:0xf bank_mask:0xf
 v_mfma_f32_16x16x32_bf16 v[12:15], v[16:19], v[216:219], v[12:15]
 v_and_b32_dpp v16, v25, v8 row_newbcast:12 row_mask:0xf bank_mask:0xf
 v_and_b32_dpp v17, v25, v9 row_newbcast:12 row_mask:0xf bank_mask:0xf
 v_and_b32_dpp v18, v25, v10 row_newbcast:12 row_mask:0xf bank_mask:0xf
 v_and_b32_dpp v19, v25, v11 row_newbcast:12 row_mask:0xf bank_mask:0xf
 v_mfma_f32_16x16x32_bf16 v[12:15], v[20:23], v[220:223], v[12:15]
 v_and_b32_dpp v20, v26, v8 row_newbcast:12 row_mask:0xf bank_mask:0xf
 v_and_b32_dpp v21, v26, v9 row_newbcast:12 row_mask:0xf bank_mask:0xf
 v_and_b32_dpp v22, v26, v10 row_newbcast:12 row_mask:0xf bank_mask:0xf
 v_and_b32_dpp v23, v26, v11 row_newbcast:12 row_mask:0xf bank_mask:0xf
 v_mfma_f32_16x16x32_bf16 v[12:15], v[16:19], v[224:227], v[12:15]
 v_and_b32_dpp v16, v25, v8 row_newbcast:13 row_mask:0xf bank_mask:0xf
 v_and_b32_dpp v17, v25, v9 row_newbcast:13 row_mask:0xf bank_mask:0xf
 v_and_b32_dpp v18, v25, v10 row_newbcast:13 row_mask:0xf bank_mask:0xf
 v_and_b32_dpp v19, v25, v11 row_newbcast:13 row_mask:0xf bank_mask:0xf
 v_mfma_f32_16x16x32_bf16 v[12:15], v[20:23], v[228:231], v[12:15]
 v_and_b32_dpp v20, v26, v8 row_newbcast:13 row_mask:0xf bank_mask:0xf
 v_and_b32_dpp v21, v26, v9 row_newbcast:13 row_mask:0xf bank_mask:0xf
 v_and_b32_dpp v22, v26, v10 row_newbcast:13 row_mask:0xf bank_mask:0xf
 v_and_b32_dpp v23, v26, v11 row_newbcast:13 row_mask:0xf bank_mask:0xf
 v_mfma_f32_16x16x32_bf16 v[12:15], v[16:19], v[232:235], v[12:15]
 v_and_b32_dpp v16, v25, v8 row_newbcast:14 row_mask:0xf bank_mask:0xf
 v_and_b32_dpp v17, v25, v9 row_newbcast:14 row_mask:0xf bank_mask:0xf
 v_and_b32_dpp v18, v25, v10 row_newbcast:14 row_mask:0xf bank_mask:0xf
 v_and_b32_dpp v19, v25, v11 row_newbcast:14 row_mask:0xf bank_mask:0xf
 v_mfma_f32_16x16x32_bf16 v[12:15], v[20:23], v[236:239], v[12:15]
 v_and_b32_dpp v20, v26, v8 row_newbcast:14 row_mask:0xf bank_mask:0xf
 v_and_b32_dpp v21, v26, v9 row_newbcast:14 row_mask:0xf bank_mask:0xf
 v_and_b32_dpp v22, v26, v10 row_newbcast:14 row_mask:0xf bank_mask:0xf
 v_and_b32_dpp v23, v26, v11 row_newbcast:14 row_mask:0xf bank_mask:0xf
 s_waitcnt vmcnt(3)
 v_mfma_f32_16x16x32_bf16 v[12:15], v[16:19], v[240:243], v[12:15]
 v_and_b32_dpp v16, v25, v8 row_newbcast:15 row_mask:0xf bank_mask:0xf
 v_and_b32_dpp v17, v25, v9 row_newbcast:15 row_mask:0xf bank_mask:0xf
 v_and_b32_dpp v18, v25, v10 row_newbcast:15 row_mask:0xf bank_mask:0xf
 v_and_b32_dpp v19, v25, v11 row_newbcast:15 row_mask:0xf bank_mask:0xf
 s_waitcnt vmcnt(2)
 v_mfma_f32_16x16x32_bf16 v[12:15], v[20:23], v[244:247], v[12:15]
 v_and_b32_dpp v20, v26, v8 row_newbcast:15 row_mask:0xf bank_mask:0xf
 v_and_b32_dpp v21, v26, v9 row_newbcast:15 row_mask:0xf bank_mask:0xf
 v_and_b32_dpp v22, v26, v10 row_newbcast:15 row_mask:0xf bank_mask:0xf
 v_and_b32_dpp v23, v26, v11 row_newbcast:15 row_mask:0xf bank_mask:0xf
 s_waitcnt vmcnt(1)
 v_mfma_f32_16x16x32_bf16 v[12:15], v[16:19], v[248:251], v[12:15]
 s_waitcnt vmcnt(0)
 v_mfma_f32_16x16x32_bf16 v[12:15], v[20:23], v[252:255], v[12:15]
 s_nop 7
 ds_write_b128 v3, v[12:15] offset:0
 s_waitcnt lgkmcnt(0)
 s_barrier
 s_mov_b32 s44, s8
 s_mov_b32 s45, s9
 s_mov_b32 s46, 0x00400000
 s_mov_b32 s47, 0x00020000
 s_mov_b32 s48, s12
 s_mov_b32 s49, s13
 s_mov_b32 s50, 0x00000ac0
 s_mov_b32 s51, 0x00020000
 s_mov_b32 s52, s14
 s_mov_b32 s53, s15
 s_mov_b32 s54, 0x00000ac0
 s_mov_b32 s55, 0x00020000
 s_mov_b32 s56, s16
 s_mov_b32 s57, s17
 s_mov_b32 s58, 0x00000ac0
 s_mov_b32 s59, 0x00020000
 s_lshl3_add_u32 s71, s60, s2
 s_cmp_lt_u32 s71, 8
 s_cselect_b32 s39, 1, 0
 s_getreg_b32 s38, hwreg(HW_REG_XCC_ID, 0, 1)
 s_mul_i32 s38, s38, 14
 s_add_u32 s38, s38, 85
 s_and_b32 s73, s2, 7
 s_lshl_b32 s71, s73, 10
 s_add_u32 s71, s71, 589824
 v_lshl_add_u32 v16, v30, 3, s71
 s_add_u32 s72, s71, 512
 v_mov_b32 v17, s72
 s_mov_b32 s72, 598016
 v_and_b32 v18, 7, v30
 v_lshl_add_u32 v18, v18, 10, s72
 s_add_u32 s71, s71, 8192
 v_mov_b32 v19, s71
 s_lshl_b32 s30, 1, s73
 s_xor_b32 s30, s30, 255
 s_mov_b32 s31, 0
 v_mov_b32 v22, 0
 v_mov_b32 v23, 0
 v_mov_b32 v24, 0
 s_mov_b32 s36, 512
 s_mov_b32 s37, 0
 s_lshl_b32 s64, s62, 17
 s_lshl_b32 s71, s60, 8
 s_add_u32 s64, s64, s71
 buffer_load_dwordx4 v[128:131], v76, s[44:47], s64 offen offset:0
 s_cmp_eq_u32 s39, 0
 s_cbranch_scc1 L_ns0
 s_call_b64 s[80:81], L_step
L_ns0:
 s_waitcnt vmcnt(0)
 buffer_load_dwordx4 v[132:135], v76, s[44:47], s64 offen offset:1024
 s_cmp_eq_u32 s39, 0
 s_cbranch_scc1 L_ns1
 s_call_b64 s[80:81], L_step
L_ns1:
 s_waitcnt vmcnt(0)
 buffer_load_dwordx4 v[136:139], v76, s[44:47], s64 offen offset:2048
 s_cmp_eq_u32 s39, 0
 s_cbranch_scc1 L_ns2
 s_call_b64 s[80:81], L_step
L_ns2:
 s_waitcnt vmcnt(0)
 buffer_load_dwordx4 v[140:143], v76, s[44:47], s64 offen offset:3072
 s_add_u32 s64, s64, 4096
 s_cmp_eq_u32 s39, 0
 s_cbranch_scc1 L_ns3
 s_call_b64 s[80:81], L_step
L_ns3:
 s_waitcnt vmcnt(0)
 buffer_load_dwordx4 v[144:147], v76, s[44:47], s64 offen offset:0
 s_cmp_eq_u32 s39, 0
 s_cbranch_scc1 L_ns4
 s_call_b64 s[80:81], L_step
L_ns4:
 s_waitcnt vmcnt(0)
 buffer_load_dwordx4 v[148:151], v76, s[44:47], s64 offen offset:1024
 s_cmp_eq_u32 s39, 0
 s_cbranch_scc1 L_ns5
 s_call_b64 s[80:81], L_step
L_ns5:
 s_waitcnt vmcnt(0)
 buffer_load_dwordx4 v[152:155], v76, s[44:47], s64 offen offset:2048
 s_cmp_eq_u32 s39, 0
 s_cbranch_scc1 L_ns6
 s_call_b64 s[80:81], L_step
L_ns6:
 s_waitcnt vmcnt(0)
 buffer_load_dwordx4 v[156:159], v76, s[44:47], s64 offen offset:3072
 s_add_u32 s64, s64, 4096
 s_cmp_eq_u32 s39, 0
 s_cbranch_scc1 L_ns7
 s_call_b64 s[80:81], L_step
L_ns7:
 s_waitcnt vmcnt(0)
 buffer_load_dwordx4 v[160:163], v76, s[44:47], s64 offen offset:0
 s_cmp_eq_u32 s39, 0
 s_cbranch_scc1 L_ns8
 s_call_b64 s[80:81], L_step
L_ns8:
 s_waitcnt vmcnt(0)
 buffer_load_dwordx4 v[164:167], v76, s[44:47], s64 offen offset:1024
 s_cmp_eq_u32 s39, 0
 s_cbranch_scc1 L_ns9
 s_call_b64 s[80:81], L_step
L_ns9:
 s_waitcnt vmcnt(0)
 buffer_load_dwordx4 v[168:171], v76, s[44:47], s64 offen offset:2048
 s_cmp_eq_u32 s39, 0
 s_cbranch_scc1 L_ns10
 s_call_b64 s[80:81], L_step
L_ns10:
 s_waitcnt vmcnt(0)
 buffer_load_dwordx4 v[172:175], v76, s[44:47], s64 offen offset:3072
 s_add_u32 s64, s64, 4096
 s_cmp_eq_u32 s39, 0
 s_cbranch_scc1 L_ns11
 s_call_b64 s[80:81], L_step
L_ns11:
 s_waitcnt vmcnt(0)
 buffer_load_dwordx4 v[176:179], v76, s[44:47], s64 offen offset:0
 s_cmp_eq_u32 s39, 0
 s_cbranch_scc1 L_ns12
 s_call_b64 s[80:81], L_step
L_ns12:
 s_waitcnt vmcnt(0)
 buffer_load_dwordx4 v[180:183], v76, s[44:47], s64 offen offset:1024
 s_cmp_eq_u32 s39, 0
 s_cbranch_scc1 L_ns13
 s_call_b64 s[80:81], L_step
L_ns13:
 s_waitcnt vmcnt(0)
 buffer_load_dwordx4 v[184:187], v76, s[44:47], s64 offen offset:2048
 s_cmp_eq_u32 s39, 0
 s_cbranch_scc1 L_ns14
 s_call_b64 s[80:81], L_step
L_ns14:
 s_waitcnt vmcnt(0)
 buffer_load_dwordx4 v[188:191], v76, s[44:47], s64 offen offset:3072
 s_add_u32 s64, s64, 4096
 s_cmp_eq_u32 s39, 0
 s_cbranch_scc1 L_ns15
 s_call_b64 s[80:81], L_step
L_ns15:
 s_waitcnt vmcnt(0)
 buffer_load_dwordx4 v[192:195], v76, s[44:47], s64 offen offset:0
 s_cmp_eq_u32 s39, 0
 s_cbranch_scc1 L_ns16
 s_call_b64 s[80:81], L_step
L_ns16:
 s_waitcnt vmcnt(0)
 buffer_load_dwordx4 v[196:199], v76, s[44:47], s64 offen offset:1024
 s_cmp_eq_u32 s39, 0
 s_cbranch_scc1 L_ns17
 s_call_b64 s[80:81], L_step
L_ns17:
 s_waitcnt vmcnt(0)
 buffer_load_dwordx4 v[200:203], v76, s[44:47], s64 offen offset:2048
 s_cmp_eq_u32 s39, 0
 s_cbranch_scc1 L_ns18
 s_call_b64 s[80:81], L_step
L_ns18:
 s_waitcnt vmcnt(0)
 buffer_load_dwordx4 v[204:207], v76, s[44:47], s64 offen offset:3072
 s_add_u32 s64, s64, 4096
 s_cmp_eq_u32 s39, 0
 s_cbranch_scc1 L_ns19
 s_call_b64 s[80:81], L_step
L_ns19:
 s_waitcnt vmcnt(0)
 buffer_load_dwordx4 v[208:211], v76, s[44:47], s64 offen offset:0
 s_cmp_eq_u32 s39, 0
 s_cbranch_scc1 L_ns20
 s_call_b64 s[80:81], L_step
L_ns20:
 s_waitcnt vmcnt(0)
 buffer_load_dwordx4 v[212:215], v76, s[44:47], s64 offen offset:1024
 s_cmp_eq_u32 s39, 0
 s_cbranch_scc1 L_ns21
 s_call_b64 s[80:81], L_step
L_ns21:
 s_waitcnt vmcnt(0)
 buffer_load_dwordx4 v[216:219], v76, s[44:47], s64 offen offset:2048
 s_cmp_eq_u32 s39, 0
 s_cbranch_scc1 L_ns22
 s_call_b64 s[80:81], L_step
L_ns22:
 s_waitcnt vmcnt(0)
 buffer_load_dwordx4 v[220:223], v76, s[44:47], s64 offen offset:3072
 s_add_u32 s64, s64, 4096
 s_cmp_eq_u32 s39, 0
 s_cbranch_scc1 L_ns23
 s_call_b64 s[80:81], L_step
L_ns23:
 s_waitcnt vmcnt(0)
 buffer_load_dwordx4 v[224:227], v76, s[44:47], s64 offen offset:0
 s_cmp_eq_u32 s39, 0
 s_cbranch_scc1 L_ns24
 s_call_b64 s[80:81], L_step
L_ns24:
 s_waitcnt vmcnt(0)
 buffer_load_dwordx4 v[228:231], v76, s[44:47], s64 offen offset:1024
 s_cmp_eq_u32 s39, 0
 s_cbranch_scc1 L_ns25
 s_call_b64 s[80:81], L_step
L_ns25:
 s_waitcnt vmcnt(0)
 buffer_load_dwordx4 v[232:235], v76, s[44:47], s64 offen offset:2048
 s_cmp_eq_u32 s39, 0
 s_cbranch_scc1 L_ns26
 s_call_b64 s[80:81], L_step
L_ns26:
 s_waitcnt vmcnt(0)
 buffer_load_dwordx4 v[236:239], v76, s[44:47], s64 offen offset:3072
 s_add_u32 s64, s64, 4096
 s_cmp_eq_u32 s39, 0
 s_cbranch_scc1 L_ns27
 s_call_b64 s[80:81], L_step
L_ns27:
 s_waitcnt vmcnt(0)
 buffer_load_dwordx4 v[240:243], v76, s[44:47], s64 offen offset:0
 s_cmp_eq_u32 s39, 0
 s_cbranch_scc1 L_ns28
 s_call_b64 s[80:81], L_step
L_ns28:
 s_waitcnt vmcnt(0)
 buffer_load_dwordx4 v[244:247], v76, s[44:47], s64 offen offset:1024
 s_cmp_eq_u32 s39, 0
 s_cbranch_scc1 L_ns29
 s_call_b64 s[80:81], L_step
L_ns29:
 s_waitcnt vmcnt(0)
 buffer_load_dwordx4 v[248:251], v76, s[44:47], s64 offen offset:2048
 s_cmp_eq_u32 s39, 0
 s_cbranch_scc1 L_ns30
 s_call_b64 s[80:81], L_step
L_ns30:
 s_waitcnt vmcnt(0)
 buffer_load_dwordx4 v[252:255], v76, s[44:47], s64 offen offset:3072
 s_add_u32 s64, s64, 4096
 s_cmp_eq_u32 s39, 0
 s_cbranch_scc1 L_ns31
 s_call_b64 s[80:81], L_step
L_ns31:
 s_waitcnt vmcnt(0)
 v_subrev_f32 v56, s75, v56
 v_subrev_f32 v57, s75, v57
 v_cvt_pk_bf16_f32 v0, v56, v57
 v_lshlrev_b32 v56, 16, v0
 v_and_b32 v57, 0xffff0000, v0
 v_mul_f32 v56, s76, v56
 v_mul_f32 v57, s76, v57
 v_cvt_pk_bf16_f32 v0, v56, v57
 v_lshlrev_b32 v56, 16, v0
 v_and_b32 v57, 0xffff0000, v0
 v_subrev_f32 v58, s75, v58
 v_subrev_f32 v59, s75, v59
 v_cvt_pk_bf16_f32 v0, v58, v59
 v_lshlrev_b32 v58, 16, v0
 v_and_b32 v59, 0xffff0000, v0
 v_mul_f32 v58, s76, v58
 v_mul_f32 v59, s76, v59
 v_cvt_pk_bf16_f32 v0, v58, v59
 v_lshlrev_b32 v58, 16, v0
 v_and_b32 v59, 0xffff0000, v0
 v_subrev_f32 v60, s75, v60
 v_subrev_f32 v61, s75, v61
 v_cvt_pk_bf16_f32 v0, v60, v61
 v_lshlrev_b32 v60, 16, v0
 v_and_b32 v61, 0xffff0000, v0
 v_mul_f32 v60, s76, v60
 v_mul_f32 v61, s76, v61
 v_cvt_pk_bf16_f32 v0, v60, v61
 v_lshlrev_b32 v60, 16, v0
 v_and_b32 v61, 0xffff0000, v0
 v_subrev_f32 v62, s75, v62
 v_subrev_f32 v63, s75, v63
 v_cvt_pk_bf16_f32 v0, v62, v63
 v_lshlrev_b32 v62, 16, v0
 v_and_b32 v63, 0xffff0000, v0
 v_mul_f32 v62, s76, v62
 v_mul_f32 v63, s76, v63
 v_cvt_pk_bf16_f32 v0, v62, v63
 v_lshlrev_b32 v62, 16, v0
 v_and_b32 v63, 0xffff0000, v0
 v_lshlrev_b32 v70, 16, v53
 v_and_b32 v71, 0xffff0000, v53
 v_mov_b32 v73, v70
 v_mov_b32 v74, v71
 v_subrev_f32 v73, s75, v73
 v_subrev_f32 v74, s75, v74
 v_cvt_pk_bf16_f32 v0, v73, v74
 v_lshlrev_b32 v73, 16, v0
 v_and_b32 v74, 0xffff0000, v0
 v_mul_f32 v73, s76, v73
 v_mul_f32 v74, s76, v74
 v_cvt_pk_bf16_f32 v0, v73, v74
 v_lshlrev_b32 v73, 16, v0
 v_and_b32 v74, 0xffff0000, v0
 v_add_f32 v32, v56, v57
 v_add_f32 v33, v58, v59
 v_add_f32 v34, v60, v61
 v_add_f32 v35, v62, v63
 v_add_f32 v32, v32, v33
 v_add_f32 v34, v34, v35
 v_add_f32 v32, v32, v34
 s_nop 1
 v_add_f32_dpp v32, v32, v32 quad_perm:[1,0,3,2] row_mask:0xf bank_mask:0xf
 s_nop 1
 v_add_f32_dpp v32, v32, v32 quad_perm:[2,3,0,1] row_mask:0xf bank_mask:0xf
 s_nop 1
 v_add_f32_dpp v32, v32, v32 row_half_mirror row_mask:0xf bank_mask:0xf
 s_nop 1
 v_add_f32_dpp v32, v32, v32 row_mirror row_mask:0xf bank_mask:0xf
 s_nop 1
 v_add_f32_dpp v32, v32, v32 row_bcast:15 row_mask:0xa bank_mask:0xf
 s_nop 1
 v_add_f32_dpp v32, v32, v32 row_bcast:31 row_mask:0xc bank_mask:0xf
 v_mul_f32 v32, 0x3b000000, v32
 s_nop 0
 v_readlane_b32 s71, v32, 63
 v_cvt_pk_bf16_f32 v41, v32, v32
 v_and_b32 v41, 0xffff0000, v41
 v_subrev_f32 v33, s71, v56
 v_subrev_f32 v34, s71, v57
 v_subrev_f32 v35, s71, v58
 v_subrev_f32 v36, s71, v59
 v_subrev_f32 v37, s71, v60
 v_subrev_f32 v38, s71, v61
 v_subrev_f32 v39, s71, v62
 v_subrev_f32 v40, s71, v63
 v_readlane_b32 s73, v41, 63
 v_mul_f32 v32, v33, v33
 v_fmac_f32 v32, v34, v34
 v_fmac_f32 v32, v35, v35
 v_fmac_f32 v32, v36, v36
 v_fmac_f32 v32, v37, v37
 v_fmac_f32 v32, v38, v38
 v_fmac_f32 v32, v39, v39
 v_fmac_f32 v32, v40, v40
 s_nop 1
 v_add_f32_dpp v32, v32, v32 quad_perm:[1,0,3,2] row_mask:0xf bank_mask:0xf
 s_nop 1
 v_add_f32_dpp v32, v32, v32 quad_perm:[2,3,0,1] row_mask:0xf bank_mask:0xf
 s_nop 1
 v_add_f32_dpp v32, v32, v32 row_half_mirror row_mask:0xf bank_mask:0xf
 s_nop 1
 v_add_f32_dpp v32, v32, v32 row_mirror row_mask:0xf bank_mask:0xf
 s_nop 1
 v_add_f32_dpp v32, v32, v32 row_bcast:15 row_mask:0xa bank_mask:0xf
 s_nop 1
 v_add_f32_dpp v32, v32, v32 row_bcast:31 row_mask:0xc bank_mask:0xf
 v_mul_f32 v32, 0x3b000000, v32
 v_cvt_pk_bf16_f32 v32, v32, v32
 v_and_b32 v32, 0xffff0000, v32
 v_add_f32 v32, 0x3727c5ac, v32
 v_cvt_pk_bf16_f32 v32, v32, v32
 v_and_b32 v32, 0xffff0000, v32
 v_sqrt_f32 v32, v32
 s_nop 0
 v_cvt_pk_bf16_f32 v32, v32, v32
 v_and_b32 v32, 0xffff0000, v32
 v_rcp_f32 v32, v32
 s_nop 1
 v_readlane_b32 s74, v32, 63
 s_nop 1
 v_subrev_f32 v73, s73, v73
 v_subrev_f32 v74, s73, v74
 v_cvt_pk_bf16_f32 v0, v73, v74
 v_lshlrev_b32 v73, 16, v0
 v_and_b32 v74, 0xffff0000, v0
 v_mul_f32 v73, s74, v73
 v_mul_f32 v74, s74, v74
 v_cvt_pk_bf16_f32 v0, v73, v74
 v_lshlrev_b32 v73, 16, v0
 v_and_b32 v74, 0xffff0000, v0
 s_mov_b32 s83, 0xbdd2d3e8
 v_mov_b32 v63, 0xc0135761
 v_mov_b32 v68, 0
 v_mov_b32 v69, 0
 v_lshlrev_b32 v56, 2, v30
 s_mov_b32 s71, 11
L_mlp:
 buffer_load_dword v57, v56, s[48:51], 0 offen
 buffer_load_dword v59, v56, s[52:55], 0 offen
 buffer_load_dword v61, v56, s[56:59], 0 offen
 v_add_u32 v56, 256, v56
 s_cmp_eq_u32 s39, 0
 s_cbranch_scc1 L_ns32
 s_call_b64 s[80:81], L_step
L_ns32:
 s_waitcnt vmcnt(0)
 v_and_b32 v58, 0xffff0000, v57
 v_lshlrev_b32 v57, 16, v57
 v_and_b32 v60, 0xffff0000, v59
 v_lshlrev_b32 v59, 16, v59
 v_mul_f32 v32, v73, v57
 v_mul_f32 v33, v73, v58
 v_mul_f32 v34, v74, v57
 v_mul_f32 v35, v74, v58
 v_cvt_pk_bf16_f32 v40, v32, v33
 v_lshlrev_b32 v32, 16, v40
 v_and_b32 v33, 0xffff0000, v40
 v_cvt_pk_bf16_f32 v41, v34, v35
 v_lshlrev_b32 v34, 16, v41
 v_and_b32 v35, 0xffff0000, v41
 v_add_f32 v32, v32, v59
 v_add_f32 v33, v33, v60
 v_add_f32 v34, v34, v59
 v_add_f32 v35, v35, v60
 v_cvt_pk_bf16_f32 v40, v32, v33
 v_lshlrev_b32 v32, 16, v40
 v_and_b32 v33, 0xffff0000, v40
 v_cvt_pk_bf16_f32 v41, v34, v35
 v_lshlrev_b32 v34, 16, v41
 v_and_b32 v35, 0xffff0000, v41
 v_mul_f32 v36, v32, v32
 v_mul_f32 v37, v33, v33
 v_mul_f32 v38, v34, v34
 v_mul_f32 v39, v35, v35
 v_fma_f32 v36, v36, s83, v63
 v_fma_f32 v37, v37, s83, v63
 v_fma_f32 v38, v38, s83, v63
 v_fma_f32 v39, v39, s83, v63
 v_mul_f32 v36, v36, v32
 v_mul_f32 v37, v37, v33
 v_mul_f32 v38, v38, v34
 v_mul_f32 v39, v39, v35
 v_exp_f32 v36, v36
 v_exp_f32 v37, v37
 v_exp_f32 v38, v38
 v_exp_f32 v39, v39
 s_nop 0
 v_add_f32 v36, 1.0, v36
 v_add_f32 v37, 1.0, v37
 v_add_f32 v38, 1.0, v38
 v_add_f32 v39, 1.0, v39
 v_rcp_f32 v36, v36
 v_rcp_f32 v37, v37
 v_rcp_f32 v38, v38
 v_rcp_f32 v39, v39
 s_nop 0
 v_mul_f32 v32, v32, v36
 v_mul_f32 v33, v33, v37
 v_mul_f32 v34, v34, v38
 v_mul_f32 v35, v35, v39
 v_cvt_pk_bf16_f32 v40, v32, v33
 v_cvt_pk_bf16_f32 v41, v34, v35
 v_dot2_f32_bf16 v68, v40, v61, v68
 v_dot2_f32_bf16 v69, v41, v61, v69
 s_sub_u32 s71, s71, 1
 s_cmp_lg_u32 s71, 0
 s_cbranch_scc1 L_mlp
 s_nop 1
 s_nop 0
 v_add_f32_dpp v68, v68, v68 quad_perm:[1,0,3,2] row_mask:0xf bank_mask:0xf
 v_add_f32_dpp v69, v69, v69 quad_perm:[1,0,3,2] row_mask:0xf bank_mask:0xf
 s_nop 0
 v_add_f32_dpp v68, v68, v68 quad_perm:[2,3,0,1] row_mask:0xf bank_mask:0xf
 v_add_f32_dpp v69, v69, v69 quad_perm:[2,3,0,1] row_mask:0xf bank_mask:0xf
 s_nop 0
 v_add_f32_dpp v68, v68, v68 row_half_mirror row_mask:0xf bank_mask:0xf
 v_add_f32_dpp v69, v69, v69 row_half_mirror row_mask:0xf bank_mask:0xf
 s_nop 0
 v_add_f32_dpp v68, v68, v68 row_mirror row_mask:0xf bank_mask:0xf
 v_add_f32_dpp v69, v69, v69 row_mirror row_mask:0xf bank_mask:0xf
 s_nop 0
 v_add_f32_dpp v68, v68, v68 row_bcast:15 row_mask:0xa bank_mask:0xf
 v_add_f32_dpp v69, v69, v69 row_bcast:15 row_mask:0xa bank_mask:0xf
 s_nop 0
 v_add_f32_dpp v68, v68, v68 row_bcast:31 row_mask:0xc bank_mask:0xf
 v_add_f32_dpp v69, v69, v69 row_bcast:31 row_mask:0xc bank_mask:0xf
 v_cvt_pk_bf16_f32 v0, v68, v69
 v_lshlrev_b32 v68, 16, v0
 v_and_b32 v69, 0xffff0000, v0
 v_lshlrev_b32 v54, 16, v54
 v_add_f32 v68, v68, v54
 v_add_f32 v69, v69, v54
 v_cvt_pk_bf16_f32 v0, v68, v69
 v_lshlrev_b32 v68, 16, v0
 v_and_b32 v69, 0xffff0000, v0
 s_mov_b32 s71, 0x05040100
 s_mov_b32 s72, 0x07060302
 v_perm_b32 v96, v132, v128, s71
 v_perm_b32 v100, v132, v128, s72
 v_perm_b32 v104, v133, v129, s71
 v_perm_b32 v108, v133, v129, s72
 v_perm_b32 v112, v134, v130, s71
 v_perm_b32 v116, v134, v130, s72
 v_perm_b32 v120, v135, v131, s71
 v_perm_b32 v124, v135, v131, s72
 v_perm_b32 v97, v140, v136, s71
 v_perm_b32 v101, v140, v136, s72
 v_perm_b32 v105, v141, v137, s71
 v_perm_b32 v109, v141, v137, s72
 v_perm_b32 v113, v142, v138, s71
 v_perm_b32 v117, v142, v138, s72
 v_perm_b32 v121, v143, v139, s71
 v_perm_b32 v125, v143, v139, s72
 v_perm_b32 v98, v148, v144, s71
 v_perm_b32 v102, v148, v144, s72
 v_perm_b32 v106, v149, v145, s71
 v_perm_b32 v110, v149, v145, s72
 v_perm_b32 v114, v150, v146, s71
 v_perm_b32 v118, v150, v146, s72
 v_perm_b32 v122, v151, v147, s71
 v_perm_b32 v126, v151, v147, s72
 v_perm_b32 v99, v156, v152, s71
 v_perm_b32 v103, v156, v152, s72
 v_perm_b32 v107, v157, v153, s71
 v_perm_b32 v111, v157, v153, s72
 v_perm_b32 v115, v158, v154, s71
 v_perm_b32 v119, v158, v154, s72
 v_perm_b32 v123, v159, v155, s71
 v_perm_b32 v127, v159, v155, s72
 v_perm_b32 v128, v164, v160, s71
 v_perm_b32 v132, v164, v160, s72
 v_perm_b32 v136, v165, v161, s71
 v_perm_b32 v140, v165, v161, s72
 v_perm_b32 v144, v166, v162, s71
 v_perm_b32 v148, v166, v162, s72
 v_perm_b32 v152, v167, v163, s71
 v_perm_b32 v156, v167, v163, s72
 v_perm_b32 v129, v172, v168, s71
 v_perm_b32 v133, v172, v168, s72
 v_perm_b32 v137, v173, v169, s71
 v_perm_b32 v141, v173, v169, s72
 v_perm_b32 v145, v174, v170, s71
 v_perm_b32 v149, v174, v170, s72
 v_perm_b32 v153, v175, v171, s71
 v_perm_b32 v157, v175, v171, s72
 v_perm_b32 v130, v180, v176, s71
 v_perm_b32 v134, v180, v176, s72
 v_perm_b32 v138, v181, v177, s71
 v_perm_b32 v142, v181, v177, s72
 v_perm_b32 v146, v182, v178, s71
 v_perm_b32 v150, v182, v178, s72
 v_perm_b32 v154, v183, v179, s71
 v_perm_b32 v158, v183, v179, s72
 v_perm_b32 v131, v188, v184, s71
 v_perm_b32 v135, v188, v184, s72
 v_perm_b32 v139, v189, v185, s71
 v_perm_b32 v143, v189, v185, s72
 v_perm_b32 v147, v190, v186, s71
 v_perm_b32 v151, v190, v186, s72
 v_perm_b32 v155, v191, v187, s71
 v_perm_b32 v159, v191, v187, s72
 v_perm_b32 v160, v196, v192, s71
 v_perm_b32 v164, v196, v192, s72
 v_perm_b32 v168, v197, v193, s71
 v_perm_b32 v172, v197, v193, s72
 v_perm_b32 v176, v198, v194, s71
 v_perm_b32 v180, v198, v194, s72
 v_perm_b32 v184, v199, v195, s71
 v_perm_b32 v188, v199, v195, s72
 v_perm_b32 v161, v204, v200, s71
 v_perm_b32 v165, v204, v200, s72
 v_perm_b32 v169, v205, v201, s71
 v_perm_b32 v173, v205, v201, s72
 v_perm_b32 v177, v206, v202, s71
 v_perm_b32 v181, v206, v202, s72
 v_perm_b32 v185, v207, v203, s71
 v_perm_b32 v189, v207, v203, s72
 v_perm_b32 v162, v212, v208, s71
 v_perm_b32 v166, v212, v208, s72
 v_perm_b32 v170, v213, v209, s71
 v_perm_b32 v174, v213, v209, s72
 v_perm_b32 v178, v214, v210, s71
 v_perm_b32 v182, v214, v210, s72
 v_perm_b32 v186, v215, v211, s71
 v_perm_b32 v190, v215, v211, s72
 v_perm_b32 v163, v220, v216, s71
 v_perm_b32 v167, v220, v216, s72
 v_perm_b32 v171, v221, v217, s71
 v_perm_b32 v175, v221, v217, s72
 v_perm_b32 v179, v222, v218, s71
 v_perm_b32 v183, v222, v218, s72
 v_perm_b32 v187, v223, v219, s71
 v_perm_b32 v191, v223, v219, s72
 v_perm_b32 v192, v228, v224, s71
 v_perm_b32 v196, v228, v224, s72
 v_perm_b32 v200, v229, v225, s71
 v_perm_b32 v204, v229, v225, s72
 v_perm_b32 v208, v230, v226, s71
 v_perm_b32 v212, v230, v226, s72
 v_perm_b32 v216, v231, v227, s71
 v_perm_b32 v220, v231, v227, s72
 v_perm_b32 v193, v236, v232, s71
 v_perm_b32 v197, v236, v232, s72
 v_perm_b32 v201, v237, v233, s71
 v_perm_b32 v205, v237, v233, s72
 v_perm_b32 v209, v238, v234, s71
 v_perm_b32 v213, v238, v234, s72
 v_perm_b32 v217, v239, v235, s71
 v_perm_b32 v221, v239, v235, s72
 v_perm_b32 v194, v244, v240, s71
 v_perm_b32 v198, v244, v240, s72
 v_perm_b32 v202, v245, v241, s71
 v_perm_b32 v206, v245, v241, s72
 v_perm_b32 v210, v246, v242, s71
 v_perm_b32 v214, v246, v242, s72
 v_perm_b32 v218, v247, v243, s71
 v_perm_b32 v222, v247, v243, s72
 v_perm_b32 v195, v252, v248, s71
 v_perm_b32 v199, v252, v248, s72
 v_perm_b32 v203, v253, v249, s71
 v_perm_b32 v207, v253, v249, s72
 v_perm_b32 v211, v254, v250, s71
 v_perm_b32 v215, v254, v250, s72
 v_perm_b32 v219, v255, v251, s71
 v_perm_b32 v223, v255, v251, s72
 v_and_b32 v35, 60, v30
 ds_write_b32 v35, v72 offset:8320
 v_and_b32 v32, 3, v30
 v_mul_u32_u24 v32, 272, v32
 v_and_b32 v33, 48, v30
 v_lshl_add_u32 v32, v33, 2, v32
 v_add_u32 v32, 2048, v32
 v_mov_b32 v34, 8320
 v_and_b32 v33, 12, v30
 v_cmp_eq_u32 vcc, 0, v33
 s_nop 1
 v_cndmask_b32 v78, v34, v32, vcc
 v_cmp_eq_u32 vcc, 4, v33
 s_nop 1
 v_cndmask_b32 v79, v34, v32, vcc
 s_lshl_b32 s71, s60, 4
 v_mov_b32 v32, s71
 s_mov_b32 exec_lo, 0
 s_mov_b32 exec_hi, 0x80000000
 ds_write_b128 v32, v[68:71] offset:8256
 s_mov_b64 exec, -1
 v_and_b32 v4, 60, v30
 v_and_b32 v5, 3, v30
 v_lshlrev_b32 v5, 4, v5
 v_and_b32 v6, 2, v30
 v_lshl_add_u32 v6, v6, 3, s77
 v_and_b32 v7, 1, v30
 v_lshl_add_u32 v6, v7, 2, v6
 v_add_u32 v66, 4096, v66
 v_add_u32 v7, 8192, v66
 s_mov_b32 s84, 2097152
L_chk:
 global_load_dword v32, v77, s[22:23] sc1
 s_waitcnt vmcnt(0)
 v_readfirstlane_b32 s71, v32
 s_cmp_ge_u32 s71, 64
 s_cbranch_scc1 L_chkd
 s_sub_u32 s84, s84, 1
 s_cmp_lg_u32 s84, 0
 s_cbranch_scc1 L_chk
L_chkd:
 s_cmp_eq_u32 s39, 0
 s_cbranch_scc1 L_ctld
 s_mov_b32 s84, 256
L_ctl:
 s_call_b64 s[80:81], L_step
 s_cmp_ge_u32 s28, 54
 s_cbranch_scc1 L_ctld
 s_sub_u32 s84, s84, 1
 s_cmp_lg_u32 s84, 0
 s_cbranch_scc1 L_ctl
L_ctld:
 s_waitcnt vmcnt(0) lgkmcnt(0)
 s_barrier
 ds_read_b128 v[32:35], v72 offset:8192
 ds_read_b128 v[36:39], v72 offset:8208
 ds_read_b128 v[68:71], v5 offset:8256
 s_waitcnt lgkmcnt(0)
 v_max3_f32 v40, v32, v34, v36
 v_max_f32 v40, v40, v38
 v_sub_f32 v32, v32, v40
 v_sub_f32 v34, v34, v40
 v_sub_f32 v36, v36, v40
 v_sub_f32 v38, v38, v40
 v_mul_f32 v32, s70, v32
 v_mul_f32 v34, s70, v34
 v_mul_f32 v36, s70, v36
 v_mul_f32 v38, s70, v38
 v_exp_f32 v32, v32
 v_exp_f32 v34, v34
 v_exp_f32 v36, v36
 v_exp_f32 v38, v38
 v_mul_f32 v41, v32, v33
 v_fmac_f32 v41, v34, v35
 v_fmac_f32 v41, v36, v37
 v_fmac_f32 v41, v38, v39
 v_rcp_f32 v42, v41
 v_and_b32 v90, -2, v40
 v_and_b32 v91, -2, v41
 s_cmp_lg_u32 s60, 0
 s_cbranch_scc1 L_noml
 s_mov_b64 exec, 1
 global_store_dwordx2 v92, v[90:91], s[6:7] sc1
 s_mov_b64 exec, -1
L_noml:
 v_mul_f32 v80, v32, v42
 v_mul_f32 v81, v34, v42
 v_mul_f32 v82, v36, v42
 v_mul_f32 v83, v38, v42
 s_mov_b32 s84, 2097152
 s_barrier
 ds_read_b128 v[32:35], v78 offset:0
 ds_read_b128 v[36:39], v78 offset:16
 ds_read_b128 v[40:43], v78 offset:32
 ds_read_b128 v[44:47], v78 offset:48
 ds_read_b128 v[48:51], v79 offset:0
 ds_read_b128 v[52:55], v79 offset:16
 ds_read_b128 v[56:59], v79 offset:32
 ds_read_b128 v[60:63], v79 offset:48
 s_cbranch_scc1 L_np0
 global_load_dwordx2 v[84:85], v67, s[6:7] sc1
L_np0:
 s_waitcnt lgkmcnt(7)
 v_mfma_f32_16x16x32_bf16 v[224:227], v[32:35], v[96:99], 0
 v_mfma_f32_16x16x32_bf16 v[228:231], v[32:35], v[100:103], 0
 v_mfma_f32_16x16x32_bf16 v[232:235], v[32:35], v[104:107], 0
 v_mfma_f32_16x16x32_bf16 v[236:239], v[32:35], v[108:111], 0
 s_waitcnt lgkmcnt(6)
 v_mfma_f32_16x16x32_bf16 v[224:227], v[36:39], v[128:131], v[224:227]
 v_mfma_f32_16x16x32_bf16 v[228:231], v[36:39], v[132:135], v[228:231]
 v_mfma_f32_16x16x32_bf16 v[232:235], v[36:39], v[136:139], v[232:235]
 v_mfma_f32_16x16x32_bf16 v[236:239], v[36:39], v[140:143], v[236:239]
 s_waitcnt lgkmcnt(5)
 v_mfma_f32_16x16x32_bf16 v[224:227], v[40:43], v[160:163], v[224:227]
 v_mfma_f32_16x16x32_bf16 v[228:231], v[40:43], v[164:167], v[228:231]
 v_mfma_f32_16x16x32_bf16 v[232:235], v[40:43], v[168:171], v[232:235]
 v_mfma_f32_16x16x32_bf16 v[236:239], v[40:43], v[172:175], v[236:239]
 s_waitcnt lgkmcnt(4)
 v_mfma_f32_16x16x32_bf16 v[224:227], v[44:47], v[192:195], v[224:227]
 v_mfma_f32_16x16x32_bf16 v[228:231], v[44:47], v[196:199], v[228:231]
 v_mfma_f32_16x16x32_bf16 v[232:235], v[44:47], v[200:203], v[232:235]
 v_mfma_f32_16x16x32_bf16 v[236:239], v[44:47], v[204:207], v[236:239]
 s_waitcnt lgkmcnt(0)
 v_mfma_f32_16x16x32_bf16 v[224:227], v[48:51], v[112:115], v[224:227]
 v_mfma_f32_16x16x32_bf16 v[224:227], v[52:55], v[144:147], v[224:227]
 v_mfma_f32_16x16x32_bf16 v[224:227], v[56:59], v[176:179], v[224:227]
 v_mfma_f32_16x16x32_bf16 v[224:227], v[60:63], v[208:211], v[224:227]
 v_mfma_f32_16x16x32_bf16 v[228:231], v[48:51], v[116:119], v[228:231]
 v_mfma_f32_16x16x32_bf16 v[228:231], v[52:55], v[148:151], v[228:231]
 v_mfma_f32_16x16x32_bf16 v[228:231], v[56:59], v[180:183], v[228:231]
 v_mfma_f32_16x16x32_bf16 v[228:231], v[60:63], v[212:215], v[228:231]
 v_mfma_f32_16x16x32_bf16 v[232:235], v[48:51], v[120:123], v[232:235]
 v_mfma_f32_16x16x32_bf16 v[232:235], v[52:55], v[152:155], v[232:235]
 v_mfma_f32_16x16x32_bf16 v[232:235], v[56:59], v[184:187], v[232:235]
 v_mfma_f32_16x16x32_bf16 v[232:235], v[60:63], v[216:219], v[232:235]
 v_mfma_f32_16x16x32_bf16 v[236:239], v[48:51], v[124:127], v[236:239]
 v_mul_f32 v12, v80, v224
 v_fmac_f32 v12, v81, v225
 v_fmac_f32 v12, v82, v226
 v_fmac_f32 v12, v83, v227
 v_and_b32 v12, -2, v12
 v_mfma_f32_16x16x32_bf16 v[236:239], v[52:55], v[156:159], v[236:239]
 v_mul_f32 v13, v80, v228
 v_fmac_f32 v13, v81, v229
 v_fmac_f32 v13, v82, v230
 v_fmac_f32 v13, v83, v231
 v_and_b32 v13, -2, v13
 v_mfma_f32_16x16x32_bf16 v[236:239], v[56:59], v[188:191], v[236:239]
 v_mfma_f32_16x16x32_bf16 v[236:239], v[60:63], v[220:223], v[236:239]
 v_mul_f32 v14, v80, v232
 v_fmac_f32 v14, v81, v233
 v_fmac_f32 v14, v82, v234
 v_fmac_f32 v14, v83, v235
 v_and_b32 v14, -2, v14
 s_nop 2
 v_mul_f32 v15, v80, v236
 v_fmac_f32 v15, v81, v237
 v_fmac_f32 v15, v82, v238
 v_fmac_f32 v15, v83, v239
 v_and_b32 v15, -2, v15
 s_mov_b32 exec_hi, 0
 global_store_dwordx4 v65, v[12:15], s[6:7] sc1
 s_mov_b64 exec, -1
 s_cbranch_scc1 L_end
 s_waitcnt vmcnt(1)
L_poll1:
 v_max_u32 v36, v84, v85
 v_cmp_eq_u32 vcc, -1, v36
 s_cbranch_vccz L_got1
 s_sub_u32 s84, s84, 1
 s_cmp_eq_u32 s84, 0
 s_cbranch_scc1 L_got1
 s_mov_b64 exec, vcc
 global_load_dwordx2 v[84:85], v67, s[6:7] sc1
 s_waitcnt vmcnt(0)
 s_branch L_poll1
L_got1:
 s_mov_b64 exec, -1
 global_load_dwordx2 v[240:241], v66, s[6:7] offset:-4096 sc1
 global_load_dwordx2 v[242:243], v66, s[6:7] offset:0 sc1
 global_load_dwordx2 v[244:245], v7, s[6:7] offset:-4096 sc1
 global_load_dwordx2 v[246:247], v7, s[6:7] offset:0 sc1
 v_sub_f32_dpp v86, v84, v84 quad_perm:[1,0,3,2] row_mask:0xf bank_mask:0xf
 v_mov_b32_dpp v87, v85 quad_perm:[1,0,3,2] row_mask:0xf bank_mask:0xf
 v_mul_f32 v86, s70, v86
 v_exp_f32 v86, v86
 s_mov_b32 s84, 2097152
 v_fma_f32 v86, v86, v87, v85
 v_rcp_f32 v86, v86
 s_nop 0
 v_mul_f32 v86, v86, v85
 ds_bpermute_b32 v248, v4, v86 offset:0
 ds_bpermute_b32 v249, v4, v86 offset:64
 ds_bpermute_b32 v250, v4, v86 offset:128
 ds_bpermute_b32 v251, v4, v86 offset:192
L_poll:
 s_waitcnt vmcnt(0)
 v_max3_u32 v36, v240, v241, v242
 v_max3_u32 v37, v243, v244, v245
 v_max3_u32 v36, v246, v247, v36
 v_max_u32 v36, v36, v37
 v_cmp_eq_u32 vcc, -1, v36
 s_cbranch_vccz L_got
 s_sub_u32 s84, s84, 1
 s_cmp_eq_u32 s84, 0
 s_cbranch_scc1 L_got
 s_mov_b64 exec, vcc
 global_load_dwordx2 v[240:241], v66, s[6:7] offset:-4096 sc1
 global_load_dwordx2 v[242:243], v66, s[6:7] offset:0 sc1
 global_load_dwordx2 v[244:245], v7, s[6:7] offset:-4096 sc1
 global_load_dwordx2 v[246:247], v7, s[6:7] offset:0 sc1
 s_branch L_poll
L_got:
 s_mov_b64 exec, -1
 s_waitcnt lgkmcnt(0)
 v_mul_f32 v32, v240, v248
 v_mul_f32 v33, v241, v248
 v_fmac_f32 v32, v242, v249
 v_fmac_f32 v33, v243, v249
 v_fmac_f32 v32, v244, v250
 v_fmac_f32 v33, v245, v250
 v_fmac_f32 v32, v246, v251
 v_fmac_f32 v33, v247, v251
 s_nop 0
 v_add_f32_dpp v32, v32, v32 row_ror:8 row_mask:0xf bank_mask:0xf
 v_add_f32_dpp v33, v33, v33 row_ror:8 row_mask:0xf bank_mask:0xf
 s_nop 0
 v_add_f32_dpp v32, v32, v32 row_ror:4 row_mask:0xf bank_mask:0xf
 v_add_f32_dpp v33, v33, v33 row_ror:4 row_mask:0xf bank_mask:0xf
 v_mov_b32 v34, v32
 v_mov_b32 v35, v33
 s_nop 0
 v_permlane16_swap_b32 v32, v34
 v_permlane16_swap_b32 v33, v35
 s_nop 0
 v_add_f32 v32, v32, v34
 v_add_f32 v33, v33, v35
 v_mov_b32 v34, v32
 v_mov_b32 v35, v33
 s_nop 0
 v_permlane32_swap_b32 v32, v34
 v_permlane32_swap_b32 v33, v35
 s_nop 0
 v_add_f32 v32, v32, v34
 v_add_f32 v33, v33, v35
 v_cvt_pk_bf16_f32 v0, v32, v33
 v_lshlrev_b32 v32, 16, v0
 v_and_b32 v33, 0xffff0000, v0
 v_add_f32 v32, v32, v70
 v_add_f32 v33, v33, v71
 v_cvt_pk_bf16_f32 v0, v32, v33
 v_lshlrev_b32 v32, 16, v0
 v_and_b32 v33, 0xffff0000, v0
 v_add_f32 v32, v32, v68
 v_add_f32 v33, v33, v69
 v_cvt_pk_bf16_f32 v32, v32, v33
 s_mov_b64 exec, 15
 global_store_dword v6, v32, s[20:21]
L_end:
 s_endpgm
L_step:
 global_load_dwordx2 v[20:21], v16, s[6:7] nt
 s_mov_b64 exec, s[30:31]
 global_load_dword v22, v18, s[6:7] sc1
 s_mov_b64 exec, -1
 s_waitcnt vmcnt(0)
 v_readfirstlane_b32 s28, v20
 v_add_u32 v20, v20, v21
 v_cmp_ne_u32 vcc, v22, v23
 s_nop 1
 v_add_u32_dpp v20, v20, v20 quad_perm:[1,0,3,2] row_mask:0xf bank_mask:0xf
 s_nop 1
 v_add_u32_dpp v20, v20, v20 quad_perm:[2,3,0,1] row_mask:0xf bank_mask:0xf
 s_nop 1
 v_add_u32_dpp v20, v20, v20 row_half_mirror row_mask:0xf bank_mask:0xf
 s_nop 1
 v_add_u32_dpp v20, v20, v20 row_mirror row_mask:0xf bank_mask:0xf
 s_nop 1
 v_add_u32_dpp v20, v20, v20 row_bcast:15 row_mask:0xa bank_mask:0xf
 s_nop 1
 v_add_u32_dpp v20, v20, v20 row_bcast:31 row_mask:0xc bank_mask:0xf
 v_mov_b32 v23, v22
 v_readlane_b32 s29, v20, 63
 s_or_b32 s37, s37, vcc_lo
 s_nop 0
 v_sub_u32 v25, s29, v22
 v_cndmask_b32 v24, v24, v25, vcc
 s_cmp_lt_u32 s29, s36
 s_cbranch_scc1 L_stepp
 s_add_u32 s36, s36, 1024
 s_cmp_gt_u32 s36, 6656
 s_cselect_b32 s36, -1, s36
 v_mov_b32 v26, s29
 s_mov_b64 exec, 1
 global_store_dword v19, v26, s[6:7] sc1
 s_mov_b64 exec, -1
L_stepp:
 s_cmp_lg_u32 s37, s30
 s_cbranch_scc1 L_stepd
 v_mov_b32 v25, v24
 s_nop 1
 v_add_u32_dpp v25, v25, v25 quad_perm:[1,0,3,2] row_mask:0xf bank_mask:0xf
 s_nop 1
 v_add_u32_dpp v25, v25, v25 quad_perm:[2,3,0,1] row_mask:0xf bank_mask:0xf
 s_nop 1
 v_add_u32_dpp v25, v25, v25 row_half_mirror row_mask:0xf bank_mask:0xf
 v_subrev_u32 v25, 1141, v25
 s_sub_i32 s37, 56, s28
 s_min_i32 s37, s37, 12
 s_max_i32 s37, s37, 3
 v_cvt_f32_i32 v25, v25
 v_cvt_f32_u32 v27, s37
 v_rcp_f32 v27, v27
 v_mul_f32 v25, 0x3f000000, v25
 v_mul_f32 v25, v25, v27
 v_cvt_i32_f32 v25, v25
 v_add_u32 v25, s38, v25
 v_max_i32 v25, 16, v25
 v_min_i32 v25, 124, v25
 s_mov_b64 exec, 1
 global_store_dword v17, v25, s[6:7]
 s_mov_b64 exec, -1
 s_mov_b32 s37, 0
L_stepd:
 s_setpc_b64 s[80:81]
L_codeend:
.section .rodata,"a"
.p2align 6
.amdhsa_kernel parallel_sum__gqa_block_cached__mixer_token_mlp__decode_kernel
  .amdhsa_next_free_vgpr 256
  .amdhsa_next_free_sgpr 102
  .amdhsa_accum_offset 256
  .amdhsa_group_segment_fixed_size 0
  .amdhsa_kernarg_size 104
  .amdhsa_user_sgpr_count 2
  .amdhsa_user_sgpr_kernarg_segment_ptr 1
  .amdhsa_system_sgpr_workgroup_id_x 1
  .amdhsa_float_denorm_mode_32 3
.end_amdhsa_kernel
```
